```python
import torch

def _softmax(x, axis=-1):
    return torch.softmax(x, dim=axis)
def _gelu(x):
    return torch.nn.functional.gelu(x, approximate="tanh")
def _silu(x):
    return torch.nn.functional.silu(x)
def _sigmoid(x):
    return torch.sigmoid(x)
def _layernorm(x, axis=-1, eps=1e-5):
    m = x.mean(dim=axis, keepdim=True)
    v = x.var(dim=axis, keepdim=True, unbiased=False)
    return (x - m) / torch.sqrt(v + eps)
def _scatter_add(tgt, idx, src, axis=0):
    return tgt.clone().index_add_(axis, idx, src)
def _segment_sum(src, seg, n):
    out = torch.zeros((n,) + src.shape[1:], dtype=src.dtype)
    return out.index_add_(0, seg, src)
def _pad(x, pw):
    flat = tuple(v for pair in reversed(pw) for v in pair)
    return torch.nn.functional.pad(x, flat)

kernel_name = 'standalone__instancenorm__prompt'

def setup_inputs():

    _w = (lambda a: (lambda t: t.to(torch.bfloat16) if t.is_floating_point() else t)(torch.as_tensor(a)))
    B, C, H, W = 1, 512, 2048, 32
    return {
        "x": _w(abs((lambda *s: torch.randn(*s, dtype=torch.bfloat16) * 0.05)(B, C, H, W))),
        "g": _w((lambda *s: torch.randn(*s, dtype=torch.bfloat16) * 0.05)(C) + 1.0),
        "b": _w((lambda *s: torch.randn(*s, dtype=torch.bfloat16) * 0.4)(C)),
    }

def reference(x, g, b):
    mu = x.mean(axis=(-2, -1), keepdims=True)
    var = ((x - mu) ** 2).mean(axis=(-2, -1), keepdims=True)
    xhat = (x - mu) / torch.sqrt(var + 1e-5)
    return xhat * g.reshape(1, -1, 1, 1) + b.reshape(1, -1, 1, 1)
```

```asm
; @launch grid=(256,1,1) block=(512,1,1) lds=256
.amdgcn_target "amdgcn-amd-amdhsa--gfx950"
.text
.p2align 8
.fill 1024, 4, 0xbf810000
.globl standalone__instancenorm__prompt_kernel
.p2align 8
.type standalone__instancenorm__prompt_kernel,@function
standalone__instancenorm__prompt_kernel:
    s_load_dwordx8 s[4:11], s[0:1], 0
    s_cmpk_ge_u32 s2, 256
    s_cbranch_scc1 L_end
    s_setprio 2
    v_lshrrev_b32 v2, 6, v0
    v_and_b32 v1, 63, v0
    v_lshlrev_b32 v1, 4, v1
    v_lshl_add_u32 v1, v2, 14, v1
    s_andn2_b32 s25, s2, 15
    s_and_b32 s60, s2, 3
    s_lshl2_add_u32 s25, s60, s25
    s_bfe_u32 s60, s2, 0x20002
    s_add_u32 s25, s25, s60
    s_lshl_b32 s60, s25, 17
    s_load_dwordx4 s[12:15], s[0:1], 32
    v_readfirstlane_b32 s24, v2
    s_getpc_b64 s[30:31]
L_pc:
    v_lshlrev_b32 v4, 7, v0
    v_mov_b32 v28, 0
    v_min_u32 v4, L_last-L_pc, v4
    s_cmp_lt_u32 s24, 2
    s_cbranch_scc0 L_nopf
    global_load_dword v28, v4, s[30:31]
L_nopf:
    s_lshr_b32 s26, s25, 4
    s_mov_b32 s32, s60
    s_and_b32 s62, s24, 3
    s_lshl_b32 s62, s62, 12
    s_add_u32 s32, s32, s62
    s_xor_b32 s33, s32, 0x1000
    s_xor_b32 s34, s32, 0x2000
    s_xor_b32 s35, s32, 0x3000
    s_mov_b32 s18, 0x4000000
    s_mov_b32 s19, 0x20000
    v_and_b32 v3, 3, v2
    v_lshl_add_u32 v3, v3, 12, v1
    v_add_u32 v3, s60, v3
    s_cmp_lt_u32 s2, 16
    s_cselect_b32 s62, s24, 0
    s_cmp_ge_u32 s62, 6
    s_cbranch_scc1 L_probe
    s_waitcnt lgkmcnt(0)
L_first:
    global_load_dwordx4 v[32:35], v3, s[4:5] offset:0 nt
    global_load_dwordx4 v[36:39], v3, s[4:5] offset:1024 nt
    global_load_dwordx4 v[40:43], v3, s[4:5] offset:2048 nt
    global_load_dwordx4 v[44:47], v3, s[4:5] offset:3072 nt
    s_mov_b32 s16, s4
    s_and_b32 s17, s5, 0xffff
    s_branch L_novote
L_probe:
    s_cmp_eq_u32 s24, 7
    s_cbranch_scc0 L_tally
    s_lshr_b32 s64, s2, 2
    s_xor_b32 s64, s64, s2
    s_bfe_u32 s64, s64, 0x10001
    s_lshl_b32 s62, s2, 8
    s_or_b32 s62, s62, s64
    s_lshl_b32 s62, s62, 13
    s_add_u32 s62, s62, 0x20c0300
    s_xor_b32 s66, s62, 0x2000
    s_waitcnt lgkmcnt(0)
    s_load_dword s67, s[4:5], s62 glc
    s_load_dword s68, s[4:5], s66 glc
    s_waitcnt lgkmcnt(1)
    s_getreg_b32 s69, hwreg(HW_REG_XCC_ID)
    s_lshr_b32 s65, s69, 2
    s_xor_b32 s64, s64, s65
    s_xor_b32 s64, s64, s2
    s_and_b32 s64, s64, 1
    s_cselect_b32 s65, 8, 16
    s_lshl_b32 s65, 1, s65
    s_add_u32 s65, s65, 1
    s_getreg_b32 s66, hwreg(HW_REG_IB_STS, 8, 4)
    s_cmp_eq_u32 s66, 1
    s_cselect_b32 s69, s65, 1
    s_atomic_add s69, s[12:13], 192
    s_branch L_first
L_tally:
    s_waitcnt lgkmcnt(0)
    s_cmp_eq_u32 s2, 15
    s_cbranch_scc0 L_first
    s_mov_b32 s63, 0x100000
    s_mov_b32 s62, 0
    s_load_dword s63, s[14:15], s63 offset:4
    s_load_dword s68, s[12:13], 128 glc
L_tpoll:
    s_load_dword s66, s[12:13], 192 glc
    s_add_u32 s62, s62, 1
    s_waitcnt lgkmcnt(0)
    s_bfe_u32 s64, s66, 0x80008
    s_bfe_u32 s65, s66, 0x80010
    s_absdiff_i32 s67, s64, s65
    s_cmp_ge_u32 s67, 3
    s_cbranch_scc1 L_decide
    s_and_b32 s67, s66, 0xff
    s_cmp_ge_u32 s67, 16
    s_cbranch_scc1 L_decide
    s_cmp_lt_u32 s62, 12
    s_cbranch_scc1 L_tpoll
L_decide:
    s_cmp_gt_u32 s64, s65
    s_cselect_b32 s65, 24, 16
    s_getreg_b32 s69, hwreg(HW_REG_XCC_ID)
    s_sub_u32 s69, s69, s2
    s_and_b32 s69, s69, 7
    s_or_b32 s65, s65, s69
    s_lshl_b32 s65, s65, 24
    s_and_b32 s66, s66, 0xffffff
    s_or_b32 s64, s66, s65
    s_add_u32 s65, s63, 0x9e3779b9
    s_cmp_eq_u32 s68, 0
    s_cselect_b64 s[64:65], s[64:65], 0
    s_atomic_add_x2 s[64:65], s[12:13], 0
    s_atomic_add_x2 s[64:65], s[12:13], 64
    s_atomic_add_x2 s[64:65], s[12:13], 128
    s_branch L_first
L_novote:
    buffer_load_dwordx4 v[48:51], v1, s[16:19], s33 offen offset:0 nt
    buffer_load_dwordx4 v[52:55], v1, s[16:19], s33 offen offset:1024 nt
    buffer_load_dwordx4 v[56:59], v1, s[16:19], s33 offen offset:2048 nt
    buffer_load_dwordx4 v[60:63], v1, s[16:19], s33 offen offset:3072 nt
    s_andn2_b32 s61, s25, 1
    s_lshl_b32 s61, s61, 1
    s_load_dword s44, s[6:7], s61
    s_load_dword s46, s[8:9], s61
    s_mov_b32 s20, s10
    s_and_b32 s21, s11, 0xffff
    s_mov_b32 s22, 0x4000000
    s_mov_b32 s23, 0x20000
    s_mov_b32 s40, 0xffff0000
    s_mov_b32 s41, 0x3f803f80
    s_mov_b64 s[56:57], 0
    v_mov_b32 v29, 0
    v_and_b32 v2, 7, v0
    v_lshlrev_b32 v2, 3, v2
    v_mov_b32 v30, 0
    v_mov_b32 v31, 0
    ds_write_b64 v30, v[30:31] offset:192
    ds_write2_b32 v30, v30, v30 offset0:55 offset1:59
    s_mov_b32 s51, 99
    buffer_load_dwordx4 v[64:67], v1, s[16:19], s34 offen offset:0 nt
    buffer_load_dwordx4 v[68:71], v1, s[16:19], s34 offen offset:1024 nt
    buffer_load_dwordx4 v[72:75], v1, s[16:19], s34 offen offset:2048 nt
    buffer_load_dwordx4 v[76:79], v1, s[16:19], s34 offen offset:3072 nt
    buffer_load_dwordx4 v[80:83], v1, s[16:19], s35 offen offset:0 nt
    buffer_load_dwordx4 v[84:87], v1, s[16:19], s35 offen offset:1024 nt
    buffer_load_dwordx4 v[88:91], v1, s[16:19], s35 offen offset:2048 nt
    buffer_load_dwordx4 v[92:95], v1, s[16:19], s35 offen offset:3072 nt
    s_setprio 0
    s_cmp_lt_u32 s24, 4
    s_cbranch_scc1 L_skipY
    s_mov_b32 s58, 0
L_dtry0:
    s_lshl_b32 s60, s58, 6
    s_load_dwordx2 s[48:49], s[12:13], s60
L_dchk0:
    s_waitcnt lgkmcnt(0)
    s_cmp_lg_u32 s48, 0
    s_cbranch_scc1 L_dgot0
    s_add_u32 s58, s58, 1
    s_sleep 12
    s_cmp_lt_u32 s58, 3
    s_cbranch_scc1 L_dtry0
    s_cmp_lt_u32 s58, 200000
    s_cbranch_scc0 L_end
    v_mov_b32 v3, 0
    global_load_dwordx2 v[4:5], v3, s[12:13] sc1
    s_waitcnt vmcnt(0)
    v_readfirstlane_b32 s48, v4
    v_readfirstlane_b32 s49, v5
    s_branch L_dchk0
L_dgot0:
    s_lshr_b32 s60, s48, 24
    s_add_u32 s61, s60, s2
    s_bfe_u32 s62, s61, 0x10002
    s_xor_b32 s61, s61, s62
    s_and_b32 s61, s61, 3
    s_lshr_b32 s60, s60, 3
    s_xor_b32 s60, s60, s62
    s_xor_b32 s60, s60, s26
    s_and_b32 s60, s60, 1
    s_and_b32 s63, s24, 1
    s_lshl1_add_u32 s60, s60, s63
    s_lshl2_add_u32 s64, s63, s60
    s_lshr_b32 s65, s10, 12
    s_xor_b32 s66, s64, 1
    s_add_u32 s64, s64, s65
    s_add_u32 s66, s66, s65
    s_lshr_b32 s64, s64, 3
    s_lshr_b32 s66, s66, 3
    v_bfe_u32 v4, v0, 4, 2
    v_and_b32 v5, 15, v0
    v_lshlrev_b32 v5, 4, v5
    v_lshl_add_u32 v5, v4, 15, v5
    v_lshl_add_u32 v5, s63, 14, v5
    v_lshrrev_b32 v6, 7, v0
    v_add_u32 v7, s64, v4
    v_xor_b32 v7, v7, v6
    v_and_b32 v7, 3, v7
    v_lshl_add_u32 v28, v7, 8, v5
    v_add_u32 v7, s66, v4
    v_xor_b32 v7, v7, v6
    v_and_b32 v7, 3, v7
    v_lshl_add_u32 v29, v7, 8, v5
    s_lshl_b32 s60, s60, 12
    s_lshl_b32 s63, s61, 19
    s_add_u32 s60, s60, s63
    s_and_b32 s63, s25, 0x1f2
    s_xor_b32 s63, s63, 0x100
    s_lshl_b32 s64, s63, 17
    s_add_u32 s36, s60, s64
    s_xor_b32 s37, s36, 0x1000
    s_xor_b32 s39, s36, 0x20000
    s_xor_b32 s38, s36, 0x21000
    s_lshl2_add_u32 s60, s61, s63
    s_lshl_b32 s60, s60, 1
    s_load_dword s45, s[6:7], s60
    s_load_dword s47, s[8:9], s60
    s_lshr_b32 s63, s2, 3
    s_lshl2_add_u32 s61, s63, s61
    s_lshl2_add_u32 s56, s61, s62
    s_lshl_b32 s56, s56, 10
    s_add_u32 s56, s56, 0x100000
    s_xor_b32 s57, s56, 0x400
    buffer_load_dwordx4 v[96:99], v1, s[16:19], s36 offen offset:0 nt
    buffer_load_dwordx4 v[100:103], v1, s[16:19], s36 offen offset:1024 nt
    buffer_load_dwordx4 v[104:107], v28, s[16:19], s36 offen offset:2048 nt
    buffer_load_dwordx4 v[108:111], v28, s[16:19], s36 offen offset:3072 nt
    s_branch L_joinY
L_skipY:
    s_waitcnt vmcnt(0)
L_joinY:
    s_waitcnt vmcnt(19)
    v_mov_b32 v12, 0
    v_mov_b32 v13, 0
    v_dot2c_f32_bf16 v12, s41, v32
    v_dot2c_f32_bf16 v13, v32, v32
    v_dot2c_f32_bf16 v12, s41, v33
    v_dot2c_f32_bf16 v13, v33, v33
    v_dot2c_f32_bf16 v12, s41, v34
    v_dot2c_f32_bf16 v13, v34, v34
    v_dot2c_f32_bf16 v12, s41, v35
    v_dot2c_f32_bf16 v13, v35, v35
    s_waitcnt vmcnt(18)
    v_dot2c_f32_bf16 v12, s41, v36
    v_dot2c_f32_bf16 v13, v36, v36
    v_dot2c_f32_bf16 v12, s41, v37
    v_dot2c_f32_bf16 v13, v37, v37
    v_dot2c_f32_bf16 v12, s41, v38
    v_dot2c_f32_bf16 v13, v38, v38
    v_dot2c_f32_bf16 v12, s41, v39
    v_dot2c_f32_bf16 v13, v39, v39
    s_waitcnt vmcnt(17)
    v_dot2c_f32_bf16 v12, s41, v40
    v_dot2c_f32_bf16 v13, v40, v40
    v_dot2c_f32_bf16 v12, s41, v41
    v_dot2c_f32_bf16 v13, v41, v41
    v_dot2c_f32_bf16 v12, s41, v42
    v_dot2c_f32_bf16 v13, v42, v42
    v_dot2c_f32_bf16 v12, s41, v43
    v_dot2c_f32_bf16 v13, v43, v43
    s_waitcnt vmcnt(16)
    v_dot2c_f32_bf16 v12, s41, v44
    v_dot2c_f32_bf16 v13, v44, v44
    v_dot2c_f32_bf16 v12, s41, v45
    v_dot2c_f32_bf16 v13, v45, v45
    v_dot2c_f32_bf16 v12, s41, v46
    v_dot2c_f32_bf16 v13, v46, v46
    v_dot2c_f32_bf16 v12, s41, v47
    v_dot2c_f32_bf16 v13, v47, v47
    s_waitcnt vmcnt(15)
    v_dot2c_f32_bf16 v12, s41, v48
    v_dot2c_f32_bf16 v13, v48, v48
    v_dot2c_f32_bf16 v12, s41, v49
    v_dot2c_f32_bf16 v13, v49, v49
    v_dot2c_f32_bf16 v12, s41, v50
    v_dot2c_f32_bf16 v13, v50, v50
    v_dot2c_f32_bf16 v12, s41, v51
    v_dot2c_f32_bf16 v13, v51, v51
    s_waitcnt vmcnt(14)
    v_dot2c_f32_bf16 v12, s41, v52
    v_dot2c_f32_bf16 v13, v52, v52
    v_dot2c_f32_bf16 v12, s41, v53
    v_dot2c_f32_bf16 v13, v53, v53
    v_dot2c_f32_bf16 v12, s41, v54
    v_dot2c_f32_bf16 v13, v54, v54
    v_dot2c_f32_bf16 v12, s41, v55
    v_dot2c_f32_bf16 v13, v55, v55
    s_waitcnt vmcnt(13)
    v_dot2c_f32_bf16 v12, s41, v56
    v_dot2c_f32_bf16 v13, v56, v56
    v_dot2c_f32_bf16 v12, s41, v57
    v_dot2c_f32_bf16 v13, v57, v57
    v_dot2c_f32_bf16 v12, s41, v58
    v_dot2c_f32_bf16 v13, v58, v58
    v_dot2c_f32_bf16 v12, s41, v59
    v_dot2c_f32_bf16 v13, v59, v59
    s_waitcnt vmcnt(12)
    v_dot2c_f32_bf16 v12, s41, v60
    v_dot2c_f32_bf16 v13, v60, v60
    v_dot2c_f32_bf16 v12, s41, v61
    v_dot2c_f32_bf16 v13, v61, v61
    v_dot2c_f32_bf16 v12, s41, v62
    v_dot2c_f32_bf16 v13, v62, v62
    v_dot2c_f32_bf16 v12, s41, v63
    v_dot2c_f32_bf16 v13, v63, v63
    s_waitcnt vmcnt(11)
    v_dot2c_f32_bf16 v12, s41, v64
    v_dot2c_f32_bf16 v13, v64, v64
    v_dot2c_f32_bf16 v12, s41, v65
    v_dot2c_f32_bf16 v13, v65, v65
    v_dot2c_f32_bf16 v12, s41, v66
    v_dot2c_f32_bf16 v13, v66, v66
    v_dot2c_f32_bf16 v12, s41, v67
    v_dot2c_f32_bf16 v13, v67, v67
    s_waitcnt vmcnt(10)
    v_dot2c_f32_bf16 v12, s41, v68
    v_dot2c_f32_bf16 v13, v68, v68
    v_dot2c_f32_bf16 v12, s41, v69
    v_dot2c_f32_bf16 v13, v69, v69
    v_dot2c_f32_bf16 v12, s41, v70
    v_dot2c_f32_bf16 v13, v70, v70
    v_dot2c_f32_bf16 v12, s41, v71
    v_dot2c_f32_bf16 v13, v71, v71
    s_waitcnt vmcnt(9)
    v_dot2c_f32_bf16 v12, s41, v72
    v_dot2c_f32_bf16 v13, v72, v72
    v_dot2c_f32_bf16 v12, s41, v73
    v_dot2c_f32_bf16 v13, v73, v73
    v_dot2c_f32_bf16 v12, s41, v74
    v_dot2c_f32_bf16 v13, v74, v74
    v_dot2c_f32_bf16 v12, s41, v75
    v_dot2c_f32_bf16 v13, v75, v75
    s_waitcnt vmcnt(8)
    v_dot2c_f32_bf16 v12, s41, v76
    v_dot2c_f32_bf16 v13, v76, v76
    v_dot2c_f32_bf16 v12, s41, v77
    v_dot2c_f32_bf16 v13, v77, v77
    v_dot2c_f32_bf16 v12, s41, v78
    v_dot2c_f32_bf16 v13, v78, v78
    v_dot2c_f32_bf16 v12, s41, v79
    v_dot2c_f32_bf16 v13, v79, v79
    s_waitcnt vmcnt(7)
    v_dot2c_f32_bf16 v12, s41, v80
    v_dot2c_f32_bf16 v13, v80, v80
    v_dot2c_f32_bf16 v12, s41, v81
    v_dot2c_f32_bf16 v13, v81, v81
    v_dot2c_f32_bf16 v12, s41, v82
    v_dot2c_f32_bf16 v13, v82, v82
    v_dot2c_f32_bf16 v12, s41, v83
    v_dot2c_f32_bf16 v13, v83, v83
    s_waitcnt vmcnt(6)
    v_dot2c_f32_bf16 v12, s41, v84
    v_dot2c_f32_bf16 v13, v84, v84
    v_dot2c_f32_bf16 v12, s41, v85
    v_dot2c_f32_bf16 v13, v85, v85
    v_dot2c_f32_bf16 v12, s41, v86
    v_dot2c_f32_bf16 v13, v86, v86
    v_dot2c_f32_bf16 v12, s41, v87
    v_dot2c_f32_bf16 v13, v87, v87
    s_waitcnt vmcnt(5)
    v_dot2c_f32_bf16 v12, s41, v88
    v_dot2c_f32_bf16 v13, v88, v88
    v_dot2c_f32_bf16 v12, s41, v89
    v_dot2c_f32_bf16 v13, v89, v89
    v_dot2c_f32_bf16 v12, s41, v90
    v_dot2c_f32_bf16 v13, v90, v90
    v_dot2c_f32_bf16 v12, s41, v91
    v_dot2c_f32_bf16 v13, v91, v91
    s_waitcnt vmcnt(4)
    v_dot2c_f32_bf16 v12, s41, v92
    v_dot2c_f32_bf16 v13, v92, v92
    v_dot2c_f32_bf16 v12, s41, v93
    v_dot2c_f32_bf16 v13, v93, v93
    v_dot2c_f32_bf16 v12, s41, v94
    v_dot2c_f32_bf16 v13, v94, v94
    v_dot2c_f32_bf16 v12, s41, v95
    v_dot2c_f32_bf16 v13, v95, v95
    s_nop 2
    v_mul_f32 v8, 0x3c000000, v12
    v_fma_f32 v10, -v8, v12, v13
    v_readfirstlane_b32 s42, v8
    v_mov_b32 v3, s24
    v_lshlrev_b32 v3, 3, v3
    v_subrev_f32 v8, s42, v8
    v_mul_f32 v9, 0x43000000, v8
    v_fmac_f32 v10, v9, v8
    s_nop 0
    v_add_f32_dpp v8, v8, v8 quad_perm:[1,0,3,2] row_mask:0xf bank_mask:0xf
    v_add_f32_dpp v10, v10, v10 quad_perm:[1,0,3,2] row_mask:0xf bank_mask:0xf
    s_nop 0
    v_add_f32_dpp v8, v8, v8 quad_perm:[2,3,0,1] row_mask:0xf bank_mask:0xf
    v_add_f32_dpp v10, v10, v10 quad_perm:[2,3,0,1] row_mask:0xf bank_mask:0xf
    s_nop 0
    v_add_f32_dpp v8, v8, v8 row_half_mirror row_mask:0xf bank_mask:0xf
    v_add_f32_dpp v10, v10, v10 row_half_mirror row_mask:0xf bank_mask:0xf
    s_nop 0
    v_add_f32_dpp v8, v8, v8 row_mirror row_mask:0xf bank_mask:0xf
    v_add_f32_dpp v10, v10, v10 row_mirror row_mask:0xf bank_mask:0xf
    s_nop 0
    v_add_f32_dpp v8, v8, v8 row_bcast:15 row_mask:0xa bank_mask:0xf
    v_add_f32_dpp v10, v10, v10 row_bcast:15 row_mask:0xa bank_mask:0xf
    s_nop 0
    v_add_f32_dpp v8, v8, v8 row_bcast:31 row_mask:0xc bank_mask:0xf
    v_add_f32_dpp v10, v10, v10 row_bcast:31 row_mask:0xc bank_mask:0xf
    v_mul_f32 v9, 0x40000000, v8
    v_fma_f32 v11, -v9, v8, v10
    v_mov_b32 v10, s42
    v_fmac_f32 v10, 0x3c800000, v8
    s_mov_b32 exec_lo, 0
    s_brev_b32 exec_hi, 1
    ds_write_b64 v3, v[10:11] offset:0
    s_mov_b64 exec, -1
    s_cmp_lt_u32 s24, 4
    s_cbranch_scc0 L_skipO
    s_mov_b32 s58, 0
L_dtry1:
    s_lshl_b32 s60, s58, 6
    s_load_dwordx2 s[48:49], s[12:13], s60
L_dchk1:
    s_waitcnt lgkmcnt(0)
    s_cmp_lg_u32 s48, 0
    s_cbranch_scc1 L_dgot1
    s_add_u32 s58, s58, 1
    s_sleep 12
    s_cmp_lt_u32 s58, 3
    s_cbranch_scc1 L_dtry1
    s_cmp_lt_u32 s58, 200000
    s_cbranch_scc0 L_end
    v_mov_b32 v3, 0
    global_load_dwordx2 v[4:5], v3, s[12:13] sc1
    s_waitcnt vmcnt(0)
    v_readfirstlane_b32 s48, v4
    v_readfirstlane_b32 s49, v5
    s_branch L_dchk1
L_dgot1:
    s_lshr_b32 s60, s48, 24
    s_add_u32 s61, s60, s2
    s_bfe_u32 s62, s61, 0x10002
    s_xor_b32 s61, s61, s62
    s_and_b32 s61, s61, 3
    s_lshr_b32 s60, s60, 3
    s_xor_b32 s60, s60, s62
    s_xor_b32 s60, s60, s26
    s_and_b32 s60, s60, 1
    s_and_b32 s63, s24, 1
    s_lshl1_add_u32 s60, s60, s63
    s_lshl2_add_u32 s64, s63, s60
    s_lshr_b32 s65, s10, 12
    s_xor_b32 s66, s64, 1
    s_add_u32 s64, s64, s65
    s_add_u32 s66, s66, s65
    s_lshr_b32 s64, s64, 3
    s_lshr_b32 s66, s66, 3
    v_bfe_u32 v4, v0, 4, 2
    v_and_b32 v5, 15, v0
    v_lshlrev_b32 v5, 4, v5
    v_lshl_add_u32 v5, v4, 15, v5
    v_lshl_add_u32 v5, s63, 14, v5
    v_lshrrev_b32 v6, 7, v0
    v_add_u32 v7, s64, v4
    v_xor_b32 v7, v7, v6
    v_and_b32 v7, 3, v7
    v_lshl_add_u32 v28, v7, 8, v5
    v_add_u32 v7, s66, v4
    v_xor_b32 v7, v7, v6
    v_and_b32 v7, 3, v7
    v_lshl_add_u32 v29, v7, 8, v5
    s_lshl_b32 s60, s60, 12
    s_lshl_b32 s63, s61, 19
    s_add_u32 s60, s60, s63
    s_and_b32 s63, s25, 0x1f2
    s_xor_b32 s63, s63, 0x100
    s_lshl_b32 s64, s63, 17
    s_add_u32 s36, s60, s64
    s_xor_b32 s37, s36, 0x1000
    s_xor_b32 s39, s36, 0x20000
    s_xor_b32 s38, s36, 0x21000
    s_lshl2_add_u32 s60, s61, s63
    s_lshl_b32 s60, s60, 1
    s_load_dword s45, s[6:7], s60
    s_load_dword s47, s[8:9], s60
    s_lshr_b32 s63, s2, 3
    s_lshl2_add_u32 s61, s63, s61
    s_lshl2_add_u32 s56, s61, s62
    s_lshl_b32 s56, s56, 10
    s_add_u32 s56, s56, 0x100000
    s_xor_b32 s57, s56, 0x400
    buffer_load_dwordx4 v[96:99], v1, s[16:19], s36 offen offset:0 nt
    buffer_load_dwordx4 v[100:103], v1, s[16:19], s36 offen offset:1024 nt
    buffer_load_dwordx4 v[104:107], v28, s[16:19], s36 offen offset:2048 nt
    buffer_load_dwordx4 v[108:111], v28, s[16:19], s36 offen offset:3072 nt
L_skipO:
    s_waitcnt lgkmcnt(0)
    s_barrier
    ds_read_b64 v[10:11], v2 offset:0
    s_waitcnt lgkmcnt(0)
    v_add_f32_dpp v8, v10, v10 quad_perm:[1,0,3,2] row_mask:0xf bank_mask:0xf
    s_nop 1
    v_add_f32_dpp v8, v8, v8 quad_perm:[2,3,0,1] row_mask:0xf bank_mask:0xf
    s_nop 1
    v_add_f32_dpp v8, v8, v8 row_half_mirror row_mask:0xf bank_mask:0xf
    v_mul_f32 v8, 0x3e000000, v8
    v_sub_f32 v9, v10, v8
    v_mul_f32 v10, 0x46000000, v9
    v_fma_f32 v11, v10, v9, v11
    s_nop 1
    v_add_f32_dpp v11, v11, v11 quad_perm:[1,0,3,2] row_mask:0xf bank_mask:0xf
    s_nop 1
    v_add_f32_dpp v11, v11, v11 quad_perm:[2,3,0,1] row_mask:0xf bank_mask:0xf
    s_nop 1
    v_add_f32_dpp v11, v11, v11 row_half_mirror row_mask:0xf bank_mask:0xf
    s_and_b32 s60, s25, 1
    s_lshl_b32 s60, s60, 4
    s_lshr_b32 s61, s44, s60
    s_lshl_b32 s61, s61, 16
    s_lshr_b32 s62, s46, s60
    s_lshl_b32 s62, s62, 16
    v_cvt_pk_bf16_f32 v9, v8, v8
    v_lshlrev_b32 v9, 16, v9
    v_sub_f32 v8, v8, v9
    v_mul_f32 v8, v8, v8
    v_fmac_f32 v8, 0x37800000, v11
    v_cvt_pk_bf16_f32 v8, v8, v8
    v_lshlrev_b32 v8, 16, v8
    v_add_f32 v8, 0x3727c5ac, v8
    v_cvt_pk_bf16_f32 v8, v8, v8
    v_lshlrev_b32 v8, 16, v8
    v_sqrt_f32 v8, v8
    s_nop 0
    v_cvt_pk_bf16_f32 v8, v8, v8
    v_lshlrev_b32 v8, 16, v8
    v_rcp_f32 v8, v8
    v_mov_b32 v22, s62
    v_mul_f32 v20, s61, v8
    v_xor_b32 v21, 0x80000000, v9
    v_lshlrev_b32 v4, 16, v32
    v_and_b32 v5, s40, v32
    v_pk_add_f32 v[4:5], v[4:5], v[20:21] op_sel:[0,1] op_sel_hi:[1,1]
    v_pk_fma_f32 v[4:5], v[4:5], v[20:21], v[22:23] op_sel_hi:[1,0,0]
    v_cvt_pk_bf16_f32 v32, v4, v5
    v_lshlrev_b32 v6, 16, v33
    v_and_b32 v7, s40, v33
    v_pk_add_f32 v[6:7], v[6:7], v[20:21] op_sel:[0,1] op_sel_hi:[1,1]
    v_pk_fma_f32 v[6:7], v[6:7], v[20:21], v[22:23] op_sel_hi:[1,0,0]
    v_cvt_pk_bf16_f32 v33, v6, v7
    v_lshlrev_b32 v4, 16, v34
    v_and_b32 v5, s40, v34
    v_pk_add_f32 v[4:5], v[4:5], v[20:21] op_sel:[0,1] op_sel_hi:[1,1]
    v_pk_fma_f32 v[4:5], v[4:5], v[20:21], v[22:23] op_sel_hi:[1,0,0]
    v_cvt_pk_bf16_f32 v34, v4, v5
    v_lshlrev_b32 v6, 16, v35
    v_and_b32 v7, s40, v35
    v_pk_add_f32 v[6:7], v[6:7], v[20:21] op_sel:[0,1] op_sel_hi:[1,1]
    v_pk_fma_f32 v[6:7], v[6:7], v[20:21], v[22:23] op_sel_hi:[1,0,0]
    v_cvt_pk_bf16_f32 v35, v6, v7
    buffer_store_dwordx4 v[32:35], v1, s[20:23], s32 offen offset:0 sc0 sc1
    s_cmp_eq_u32 s24, 0
    s_cbranch_scc0 L_noz
    v_lshl_add_u32 v3, v0, 4, s56
    s_not_b32 s60, s49
    v_mov_b32 v4, s60
    v_mov_b32 v5, s60
    v_mov_b32 v6, s60
    v_mov_b32 v7, s60
    s_mov_b64 exec, 65535
    global_store_dwordx4 v3, v[4:7], s[14:15] sc0 sc1
    s_mov_b64 exec, -1
    s_nop 1
L_noz:
    buffer_load_dwordx4 v[112:115], v29, s[16:19], s37 offen offset:0 nt
    v_lshlrev_b32 v4, 16, v36
    v_and_b32 v5, s40, v36
    v_pk_add_f32 v[4:5], v[4:5], v[20:21] op_sel:[0,1] op_sel_hi:[1,1]
    v_pk_fma_f32 v[4:5], v[4:5], v[20:21], v[22:23] op_sel_hi:[1,0,0]
    v_cvt_pk_bf16_f32 v36, v4, v5
    v_lshlrev_b32 v6, 16, v37
    v_and_b32 v7, s40, v37
    v_pk_add_f32 v[6:7], v[6:7], v[20:21] op_sel:[0,1] op_sel_hi:[1,1]
    v_pk_fma_f32 v[6:7], v[6:7], v[20:21], v[22:23] op_sel_hi:[1,0,0]
    v_cvt_pk_bf16_f32 v37, v6, v7
    v_lshlrev_b32 v4, 16, v38
    v_and_b32 v5, s40, v38
    v_pk_add_f32 v[4:5], v[4:5], v[20:21] op_sel:[0,1] op_sel_hi:[1,1]
    v_pk_fma_f32 v[4:5], v[4:5], v[20:21], v[22:23] op_sel_hi:[1,0,0]
    v_cvt_pk_bf16_f32 v38, v4, v5
    v_lshlrev_b32 v6, 16, v39
    v_and_b32 v7, s40, v39
    v_pk_add_f32 v[6:7], v[6:7], v[20:21] op_sel:[0,1] op_sel_hi:[1,1]
    v_pk_fma_f32 v[6:7], v[6:7], v[20:21], v[22:23] op_sel_hi:[1,0,0]
    v_cvt_pk_bf16_f32 v39, v6, v7
    buffer_store_dwordx4 v[36:39], v1, s[20:23], s32 offen offset:1024 sc0 sc1
    v_lshlrev_b32 v4, 16, v40
    v_and_b32 v5, s40, v40
    v_pk_add_f32 v[4:5], v[4:5], v[20:21] op_sel:[0,1] op_sel_hi:[1,1]
    v_pk_fma_f32 v[4:5], v[4:5], v[20:21], v[22:23] op_sel_hi:[1,0,0]
    v_cvt_pk_bf16_f32 v40, v4, v5
    v_lshlrev_b32 v6, 16, v41
    v_and_b32 v7, s40, v41
    v_pk_add_f32 v[6:7], v[6:7], v[20:21] op_sel:[0,1] op_sel_hi:[1,1]
    v_pk_fma_f32 v[6:7], v[6:7], v[20:21], v[22:23] op_sel_hi:[1,0,0]
    v_cvt_pk_bf16_f32 v41, v6, v7
    v_lshlrev_b32 v4, 16, v42
    v_and_b32 v5, s40, v42
    v_pk_add_f32 v[4:5], v[4:5], v[20:21] op_sel:[0,1] op_sel_hi:[1,1]
    v_pk_fma_f32 v[4:5], v[4:5], v[20:21], v[22:23] op_sel_hi:[1,0,0]
    v_cvt_pk_bf16_f32 v42, v4, v5
    v_lshlrev_b32 v6, 16, v43
    v_and_b32 v7, s40, v43
    v_pk_add_f32 v[6:7], v[6:7], v[20:21] op_sel:[0,1] op_sel_hi:[1,1]
    v_pk_fma_f32 v[6:7], v[6:7], v[20:21], v[22:23] op_sel_hi:[1,0,0]
    v_cvt_pk_bf16_f32 v43, v6, v7
    buffer_store_dwordx4 v[40:43], v1, s[20:23], s32 offen offset:2048 sc0 sc1
    buffer_load_dwordx4 v[116:119], v29, s[16:19], s37 offen offset:1024 nt
    v_lshlrev_b32 v4, 16, v44
    v_and_b32 v5, s40, v44
    v_pk_add_f32 v[4:5], v[4:5], v[20:21] op_sel:[0,1] op_sel_hi:[1,1]
    v_pk_fma_f32 v[4:5], v[4:5], v[20:21], v[22:23] op_sel_hi:[1,0,0]
    v_cvt_pk_bf16_f32 v44, v4, v5
    v_lshlrev_b32 v6, 16, v45
    v_and_b32 v7, s40, v45
    v_pk_add_f32 v[6:7], v[6:7], v[20:21] op_sel:[0,1] op_sel_hi:[1,1]
    v_pk_fma_f32 v[6:7], v[6:7], v[20:21], v[22:23] op_sel_hi:[1,0,0]
    v_cvt_pk_bf16_f32 v45, v6, v7
    v_lshlrev_b32 v4, 16, v46
    v_and_b32 v5, s40, v46
    v_pk_add_f32 v[4:5], v[4:5], v[20:21] op_sel:[0,1] op_sel_hi:[1,1]
    v_pk_fma_f32 v[4:5], v[4:5], v[20:21], v[22:23] op_sel_hi:[1,0,0]
    v_cvt_pk_bf16_f32 v46, v4, v5
    v_lshlrev_b32 v6, 16, v47
    v_and_b32 v7, s40, v47
    v_pk_add_f32 v[6:7], v[6:7], v[20:21] op_sel:[0,1] op_sel_hi:[1,1]
    v_pk_fma_f32 v[6:7], v[6:7], v[20:21], v[22:23] op_sel_hi:[1,0,0]
    v_cvt_pk_bf16_f32 v47, v6, v7
    buffer_store_dwordx4 v[44:47], v1, s[20:23], s32 offen offset:3072 sc0 sc1
    s_waitcnt vmcnt(9)
    v_mov_b32 v14, 0
    v_mov_b32 v15, 0
    v_dot2c_f32_bf16 v14, s41, v96
    v_dot2c_f32_bf16 v15, v96, v96
    v_dot2c_f32_bf16 v14, s41, v97
    v_dot2c_f32_bf16 v15, v97, v97
    v_dot2c_f32_bf16 v14, s41, v98
    v_dot2c_f32_bf16 v15, v98, v98
    v_dot2c_f32_bf16 v14, s41, v99
    v_dot2c_f32_bf16 v15, v99, v99
    buffer_load_dwordx4 v[120:123], v29, s[16:19], s37 offen offset:2048 nt
    v_lshlrev_b32 v4, 16, v48
    v_and_b32 v5, s40, v48
    v_pk_add_f32 v[4:5], v[4:5], v[20:21] op_sel:[0,1] op_sel_hi:[1,1]
    v_pk_fma_f32 v[4:5], v[4:5], v[20:21], v[22:23] op_sel_hi:[1,0,0]
    v_cvt_pk_bf16_f32 v48, v4, v5
    v_lshlrev_b32 v6, 16, v49
    v_and_b32 v7, s40, v49
    v_pk_add_f32 v[6:7], v[6:7], v[20:21] op_sel:[0,1] op_sel_hi:[1,1]
    v_pk_fma_f32 v[6:7], v[6:7], v[20:21], v[22:23] op_sel_hi:[1,0,0]
    v_cvt_pk_bf16_f32 v49, v6, v7
    v_lshlrev_b32 v4, 16, v50
    v_and_b32 v5, s40, v50
    v_pk_add_f32 v[4:5], v[4:5], v[20:21] op_sel:[0,1] op_sel_hi:[1,1]
    v_pk_fma_f32 v[4:5], v[4:5], v[20:21], v[22:23] op_sel_hi:[1,0,0]
    v_cvt_pk_bf16_f32 v50, v4, v5
    v_lshlrev_b32 v6, 16, v51
    v_and_b32 v7, s40, v51
    v_pk_add_f32 v[6:7], v[6:7], v[20:21] op_sel:[0,1] op_sel_hi:[1,1]
    v_pk_fma_f32 v[6:7], v[6:7], v[20:21], v[22:23] op_sel_hi:[1,0,0]
    v_cvt_pk_bf16_f32 v51, v6, v7
    buffer_store_dwordx4 v[48:51], v1, s[20:23], s33 offen offset:0 sc0 sc1
    v_lshlrev_b32 v4, 16, v52
    v_and_b32 v5, s40, v52
    v_pk_add_f32 v[4:5], v[4:5], v[20:21] op_sel:[0,1] op_sel_hi:[1,1]
    v_pk_fma_f32 v[4:5], v[4:5], v[20:21], v[22:23] op_sel_hi:[1,0,0]
    v_cvt_pk_bf16_f32 v52, v4, v5
    v_lshlrev_b32 v6, 16, v53
    v_and_b32 v7, s40, v53
    v_pk_add_f32 v[6:7], v[6:7], v[20:21] op_sel:[0,1] op_sel_hi:[1,1]
    v_pk_fma_f32 v[6:7], v[6:7], v[20:21], v[22:23] op_sel_hi:[1,0,0]
    v_cvt_pk_bf16_f32 v53, v6, v7
    v_lshlrev_b32 v4, 16, v54
    v_and_b32 v5, s40, v54
    v_pk_add_f32 v[4:5], v[4:5], v[20:21] op_sel:[0,1] op_sel_hi:[1,1]
    v_pk_fma_f32 v[4:5], v[4:5], v[20:21], v[22:23] op_sel_hi:[1,0,0]
    v_cvt_pk_bf16_f32 v54, v4, v5
    v_lshlrev_b32 v6, 16, v55
    v_and_b32 v7, s40, v55
    v_pk_add_f32 v[6:7], v[6:7], v[20:21] op_sel:[0,1] op_sel_hi:[1,1]
    v_pk_fma_f32 v[6:7], v[6:7], v[20:21], v[22:23] op_sel_hi:[1,0,0]
    v_cvt_pk_bf16_f32 v55, v6, v7
    buffer_store_dwordx4 v[52:55], v1, s[20:23], s33 offen offset:1024 sc0 sc1
    s_barrier
    s_waitcnt vmcnt(11)
    v_dot2c_f32_bf16 v14, s41, v100
    v_dot2c_f32_bf16 v15, v100, v100
    v_dot2c_f32_bf16 v14, s41, v101
    v_dot2c_f32_bf16 v15, v101, v101
    v_dot2c_f32_bf16 v14, s41, v102
    v_dot2c_f32_bf16 v15, v102, v102
    v_dot2c_f32_bf16 v14, s41, v103
    v_dot2c_f32_bf16 v15, v103, v103
    s_waitcnt vmcnt(10)
    v_dot2c_f32_bf16 v14, s41, v104
    v_dot2c_f32_bf16 v15, v104, v104
    v_dot2c_f32_bf16 v14, s41, v105
    v_dot2c_f32_bf16 v15, v105, v105
    v_dot2c_f32_bf16 v14, s41, v106
    v_dot2c_f32_bf16 v15, v106, v106
    v_dot2c_f32_bf16 v14, s41, v107
    v_dot2c_f32_bf16 v15, v107, v107
    buffer_load_dwordx4 v[124:127], v29, s[16:19], s37 offen offset:3072 nt
    v_lshlrev_b32 v4, 16, v56
    v_and_b32 v5, s40, v56
    v_pk_add_f32 v[4:5], v[4:5], v[20:21] op_sel:[0,1] op_sel_hi:[1,1]
    v_pk_fma_f32 v[4:5], v[4:5], v[20:21], v[22:23] op_sel_hi:[1,0,0]
    v_cvt_pk_bf16_f32 v56, v4, v5
    v_lshlrev_b32 v6, 16, v57
    v_and_b32 v7, s40, v57
    v_pk_add_f32 v[6:7], v[6:7], v[20:21] op_sel:[0,1] op_sel_hi:[1,1]
    v_pk_fma_f32 v[6:7], v[6:7], v[20:21], v[22:23] op_sel_hi:[1,0,0]
    v_cvt_pk_bf16_f32 v57, v6, v7
    v_lshlrev_b32 v4, 16, v58
    v_and_b32 v5, s40, v58
    v_pk_add_f32 v[4:5], v[4:5], v[20:21] op_sel:[0,1] op_sel_hi:[1,1]
    v_pk_fma_f32 v[4:5], v[4:5], v[20:21], v[22:23] op_sel_hi:[1,0,0]
    v_cvt_pk_bf16_f32 v58, v4, v5
    v_lshlrev_b32 v6, 16, v59
    v_and_b32 v7, s40, v59
    v_pk_add_f32 v[6:7], v[6:7], v[20:21] op_sel:[0,1] op_sel_hi:[1,1]
    v_pk_fma_f32 v[6:7], v[6:7], v[20:21], v[22:23] op_sel_hi:[1,0,0]
    v_cvt_pk_bf16_f32 v59, v6, v7
    buffer_store_dwordx4 v[56:59], v1, s[20:23], s33 offen offset:2048 sc0 sc1
    v_lshlrev_b32 v4, 16, v60
    v_and_b32 v5, s40, v60
    v_pk_add_f32 v[4:5], v[4:5], v[20:21] op_sel:[0,1] op_sel_hi:[1,1]
    v_pk_fma_f32 v[4:5], v[4:5], v[20:21], v[22:23] op_sel_hi:[1,0,0]
    v_cvt_pk_bf16_f32 v60, v4, v5
    v_lshlrev_b32 v6, 16, v61
    v_and_b32 v7, s40, v61
    v_pk_add_f32 v[6:7], v[6:7], v[20:21] op_sel:[0,1] op_sel_hi:[1,1]
    v_pk_fma_f32 v[6:7], v[6:7], v[20:21], v[22:23] op_sel_hi:[1,0,0]
    v_cvt_pk_bf16_f32 v61, v6, v7
    v_lshlrev_b32 v4, 16, v62
    v_and_b32 v5, s40, v62
    v_pk_add_f32 v[4:5], v[4:5], v[20:21] op_sel:[0,1] op_sel_hi:[1,1]
    v_pk_fma_f32 v[4:5], v[4:5], v[20:21], v[22:23] op_sel_hi:[1,0,0]
    v_cvt_pk_bf16_f32 v62, v4, v5
    v_lshlrev_b32 v6, 16, v63
    v_and_b32 v7, s40, v63
    v_pk_add_f32 v[6:7], v[6:7], v[20:21] op_sel:[0,1] op_sel_hi:[1,1]
    v_pk_fma_f32 v[6:7], v[6:7], v[20:21], v[22:23] op_sel_hi:[1,0,0]
    v_cvt_pk_bf16_f32 v63, v6, v7
    buffer_store_dwordx4 v[60:63], v1, s[20:23], s33 offen offset:3072 sc0 sc1
    s_waitcnt vmcnt(12)
    v_dot2c_f32_bf16 v14, s41, v108
    v_dot2c_f32_bf16 v15, v108, v108
    v_dot2c_f32_bf16 v14, s41, v109
    v_dot2c_f32_bf16 v15, v109, v109
    v_dot2c_f32_bf16 v14, s41, v110
    v_dot2c_f32_bf16 v15, v110, v110
    v_dot2c_f32_bf16 v14, s41, v111
    v_dot2c_f32_bf16 v15, v111, v111
    s_waitcnt vmcnt(10)
    v_dot2c_f32_bf16 v14, s41, v112
    v_dot2c_f32_bf16 v15, v112, v112
    v_dot2c_f32_bf16 v14, s41, v113
    v_dot2c_f32_bf16 v15, v113, v113
    v_dot2c_f32_bf16 v14, s41, v114
    v_dot2c_f32_bf16 v15, v114, v114
    v_dot2c_f32_bf16 v14, s41, v115
    v_dot2c_f32_bf16 v15, v115, v115
    buffer_load_dwordx4 v[128:131], v29, s[16:19], s38 offen offset:0 nt
    v_lshlrev_b32 v4, 16, v64
    v_and_b32 v5, s40, v64
    v_pk_add_f32 v[4:5], v[4:5], v[20:21] op_sel:[0,1] op_sel_hi:[1,1]
    v_pk_fma_f32 v[4:5], v[4:5], v[20:21], v[22:23] op_sel_hi:[1,0,0]
    v_cvt_pk_bf16_f32 v64, v4, v5
    v_lshlrev_b32 v6, 16, v65
    v_and_b32 v7, s40, v65
    v_pk_add_f32 v[6:7], v[6:7], v[20:21] op_sel:[0,1] op_sel_hi:[1,1]
    v_pk_fma_f32 v[6:7], v[6:7], v[20:21], v[22:23] op_sel_hi:[1,0,0]
    v_cvt_pk_bf16_f32 v65, v6, v7
    v_lshlrev_b32 v4, 16, v66
    v_and_b32 v5, s40, v66
    v_pk_add_f32 v[4:5], v[4:5], v[20:21] op_sel:[0,1] op_sel_hi:[1,1]
    v_pk_fma_f32 v[4:5], v[4:5], v[20:21], v[22:23] op_sel_hi:[1,0,0]
    v_cvt_pk_bf16_f32 v66, v4, v5
    v_lshlrev_b32 v6, 16, v67
    v_and_b32 v7, s40, v67
    v_pk_add_f32 v[6:7], v[6:7], v[20:21] op_sel:[0,1] op_sel_hi:[1,1]
    v_pk_fma_f32 v[6:7], v[6:7], v[20:21], v[22:23] op_sel_hi:[1,0,0]
    v_cvt_pk_bf16_f32 v67, v6, v7
    buffer_store_dwordx4 v[64:67], v1, s[20:23], s34 offen offset:0 sc0 sc1
    v_lshlrev_b32 v4, 16, v68
    v_and_b32 v5, s40, v68
    v_pk_add_f32 v[4:5], v[4:5], v[20:21] op_sel:[0,1] op_sel_hi:[1,1]
    v_pk_fma_f32 v[4:5], v[4:5], v[20:21], v[22:23] op_sel_hi:[1,0,0]
    v_cvt_pk_bf16_f32 v68, v4, v5
    v_lshlrev_b32 v6, 16, v69
    v_and_b32 v7, s40, v69
    v_pk_add_f32 v[6:7], v[6:7], v[20:21] op_sel:[0,1] op_sel_hi:[1,1]
    v_pk_fma_f32 v[6:7], v[6:7], v[20:21], v[22:23] op_sel_hi:[1,0,0]
    v_cvt_pk_bf16_f32 v69, v6, v7
    v_lshlrev_b32 v4, 16, v70
    v_and_b32 v5, s40, v70
    v_pk_add_f32 v[4:5], v[4:5], v[20:21] op_sel:[0,1] op_sel_hi:[1,1]
    v_pk_fma_f32 v[4:5], v[4:5], v[20:21], v[22:23] op_sel_hi:[1,0,0]
    v_cvt_pk_bf16_f32 v70, v4, v5
    v_lshlrev_b32 v6, 16, v71
    v_and_b32 v7, s40, v71
    v_pk_add_f32 v[6:7], v[6:7], v[20:21] op_sel:[0,1] op_sel_hi:[1,1]
    v_pk_fma_f32 v[6:7], v[6:7], v[20:21], v[22:23] op_sel_hi:[1,0,0]
    v_cvt_pk_bf16_f32 v71, v6, v7
    buffer_store_dwordx4 v[68:71], v1, s[20:23], s34 offen offset:1024 sc0 sc1
    s_waitcnt vmcnt(10)
    v_dot2c_f32_bf16 v14, s41, v116
    v_dot2c_f32_bf16 v15, v116, v116
    v_dot2c_f32_bf16 v14, s41, v117
    v_dot2c_f32_bf16 v15, v117, v117
    v_dot2c_f32_bf16 v14, s41, v118
    v_dot2c_f32_bf16 v15, v118, v118
    v_dot2c_f32_bf16 v14, s41, v119
    v_dot2c_f32_bf16 v15, v119, v119
    s_waitcnt vmcnt(8)
    v_dot2c_f32_bf16 v14, s41, v120
    v_dot2c_f32_bf16 v15, v120, v120
    v_dot2c_f32_bf16 v14, s41, v121
    v_dot2c_f32_bf16 v15, v121, v121
    v_dot2c_f32_bf16 v14, s41, v122
    v_dot2c_f32_bf16 v15, v122, v122
    v_dot2c_f32_bf16 v14, s41, v123
    v_dot2c_f32_bf16 v15, v123, v123
    buffer_load_dwordx4 v[132:135], v29, s[16:19], s38 offen offset:1024 nt
    v_lshlrev_b32 v4, 16, v72
    v_and_b32 v5, s40, v72
    v_pk_add_f32 v[4:5], v[4:5], v[20:21] op_sel:[0,1] op_sel_hi:[1,1]
    v_pk_fma_f32 v[4:5], v[4:5], v[20:21], v[22:23] op_sel_hi:[1,0,0]
    v_cvt_pk_bf16_f32 v72, v4, v5
    v_lshlrev_b32 v6, 16, v73
    v_and_b32 v7, s40, v73
    v_pk_add_f32 v[6:7], v[6:7], v[20:21] op_sel:[0,1] op_sel_hi:[1,1]
    v_pk_fma_f32 v[6:7], v[6:7], v[20:21], v[22:23] op_sel_hi:[1,0,0]
    v_cvt_pk_bf16_f32 v73, v6, v7
    v_lshlrev_b32 v4, 16, v74
    v_and_b32 v5, s40, v74
    v_pk_add_f32 v[4:5], v[4:5], v[20:21] op_sel:[0,1] op_sel_hi:[1,1]
    v_pk_fma_f32 v[4:5], v[4:5], v[20:21], v[22:23] op_sel_hi:[1,0,0]
    v_cvt_pk_bf16_f32 v74, v4, v5
    v_lshlrev_b32 v6, 16, v75
    v_and_b32 v7, s40, v75
    v_pk_add_f32 v[6:7], v[6:7], v[20:21] op_sel:[0,1] op_sel_hi:[1,1]
    v_pk_fma_f32 v[6:7], v[6:7], v[20:21], v[22:23] op_sel_hi:[1,0,0]
    v_cvt_pk_bf16_f32 v75, v6, v7
    buffer_store_dwordx4 v[72:75], v1, s[20:23], s34 offen offset:2048 sc0 sc1
    s_waitcnt vmcnt(7)
    v_dot2c_f32_bf16 v14, s41, v124
    v_dot2c_f32_bf16 v15, v124, v124
    v_dot2c_f32_bf16 v14, s41, v125
    v_dot2c_f32_bf16 v15, v125, v125
    v_dot2c_f32_bf16 v14, s41, v126
    v_dot2c_f32_bf16 v15, v126, v126
    v_dot2c_f32_bf16 v14, s41, v127
    v_dot2c_f32_bf16 v15, v127, v127
    s_nop 2
    v_mul_f32 v8, 0x3c800000, v14
    v_fma_f32 v10, -v8, v14, v15
    v_readfirstlane_b32 s42, v8
    v_mov_b32 v3, s24
    v_lshlrev_b32 v3, 3, v3
    v_subrev_f32 v8, s42, v8
    v_mul_f32 v9, 0x42800000, v8
    v_fmac_f32 v10, v9, v8
    s_nop 0
    v_add_f32_dpp v8, v8, v8 quad_perm:[1,0,3,2] row_mask:0xf bank_mask:0xf
    v_add_f32_dpp v10, v10, v10 quad_perm:[1,0,3,2] row_mask:0xf bank_mask:0xf
    s_nop 0
    v_add_f32_dpp v8, v8, v8 quad_perm:[2,3,0,1] row_mask:0xf bank_mask:0xf
    v_add_f32_dpp v10, v10, v10 quad_perm:[2,3,0,1] row_mask:0xf bank_mask:0xf
    s_nop 0
    v_add_f32_dpp v8, v8, v8 row_half_mirror row_mask:0xf bank_mask:0xf
    v_add_f32_dpp v10, v10, v10 row_half_mirror row_mask:0xf bank_mask:0xf
    s_nop 0
    v_add_f32_dpp v8, v8, v8 row_mirror row_mask:0xf bank_mask:0xf
    v_add_f32_dpp v10, v10, v10 row_mirror row_mask:0xf bank_mask:0xf
    s_nop 0
    v_add_f32_dpp v8, v8, v8 row_bcast:15 row_mask:0xa bank_mask:0xf
    v_add_f32_dpp v10, v10, v10 row_bcast:15 row_mask:0xa bank_mask:0xf
    s_nop 0
    v_add_f32_dpp v8, v8, v8 row_bcast:31 row_mask:0xc bank_mask:0xf
    v_add_f32_dpp v10, v10, v10 row_bcast:31 row_mask:0xc bank_mask:0xf
    v_mul_f32 v9, 0x3f800000, v8
    v_fma_f32 v11, -v9, v8, v10
    v_mov_b32 v10, s42
    v_fmac_f32 v10, 0x3c800000, v8
    s_mov_b32 exec_lo, 0
    s_brev_b32 exec_hi, 1
    ds_write_b64 v3, v[10:11] offset:64
    s_mov_b64 exec, -1
    v_lshlrev_b32 v4, 16, v76
    v_and_b32 v5, s40, v76
    v_pk_add_f32 v[4:5], v[4:5], v[20:21] op_sel:[0,1] op_sel_hi:[1,1]
    v_pk_fma_f32 v[4:5], v[4:5], v[20:21], v[22:23] op_sel_hi:[1,0,0]
    v_cvt_pk_bf16_f32 v76, v4, v5
    v_lshlrev_b32 v6, 16, v77
    v_and_b32 v7, s40, v77
    v_pk_add_f32 v[6:7], v[6:7], v[20:21] op_sel:[0,1] op_sel_hi:[1,1]
    v_pk_fma_f32 v[6:7], v[6:7], v[20:21], v[22:23] op_sel_hi:[1,0,0]
    v_cvt_pk_bf16_f32 v77, v6, v7
    v_lshlrev_b32 v4, 16, v78
    v_and_b32 v5, s40, v78
    v_pk_add_f32 v[4:5], v[4:5], v[20:21] op_sel:[0,1] op_sel_hi:[1,1]
    v_pk_fma_f32 v[4:5], v[4:5], v[20:21], v[22:23] op_sel_hi:[1,0,0]
    v_cvt_pk_bf16_f32 v78, v4, v5
    v_lshlrev_b32 v6, 16, v79
    v_and_b32 v7, s40, v79
    v_pk_add_f32 v[6:7], v[6:7], v[20:21] op_sel:[0,1] op_sel_hi:[1,1]
    v_pk_fma_f32 v[6:7], v[6:7], v[20:21], v[22:23] op_sel_hi:[1,0,0]
    v_cvt_pk_bf16_f32 v79, v6, v7
    buffer_store_dwordx4 v[76:79], v1, s[20:23], s34 offen offset:3072 sc0 sc1
    s_waitcnt lgkmcnt(0)
    s_barrier
    s_cmp_eq_u32 s24, 0
    s_cbranch_scc0 L_nopub1
    ds_read_b64 v[10:11], v2 offset:64
    s_waitcnt lgkmcnt(0)
    v_add_f32_dpp v8, v10, v10 quad_perm:[1,0,3,2] row_mask:0xf bank_mask:0xf
    s_nop 1
    v_add_f32_dpp v8, v8, v8 quad_perm:[2,3,0,1] row_mask:0xf bank_mask:0xf
    s_nop 1
    v_add_f32_dpp v8, v8, v8 row_half_mirror row_mask:0xf bank_mask:0xf
    v_mul_f32 v8, 0x3e000000, v8
    v_sub_f32 v9, v10, v8
    v_mul_f32 v10, 0x45800000, v9
    v_fma_f32 v11, v10, v9, v11
    s_nop 1
    v_add_f32_dpp v11, v11, v11 quad_perm:[1,0,3,2] row_mask:0xf bank_mask:0xf
    s_nop 1
    v_add_f32_dpp v11, v11, v11 quad_perm:[2,3,0,1] row_mask:0xf bank_mask:0xf
    s_nop 1
    v_add_f32_dpp v11, v11, v11 row_half_mirror row_mask:0xf bank_mask:0xf
    v_mov_b32 v16, v8
    v_mov_b32 v17, v11
    v_readfirstlane_b32 s64, v8
    v_readfirstlane_b32 s66, v11
    s_mov_b32 s60, s56
    s_not_b32 s61, s49
    s_sub_u32 s64, s64, s61
    s_subb_u32 s65, s49, s61
    s_atomic_add_x2 s[64:65], s[14:15], s60 offset:0
    s_sub_u32 s66, s66, s61
    s_subb_u32 s67, s49, s61
    s_atomic_add_x2 s[66:67], s[14:15], s60 offset:8
L_nopub1:
    buffer_load_dwordx4 v[136:139], v29, s[16:19], s38 offen offset:2048 nt
    v_lshlrev_b32 v4, 16, v80
    v_and_b32 v5, s40, v80
    v_pk_add_f32 v[4:5], v[4:5], v[20:21] op_sel:[0,1] op_sel_hi:[1,1]
    v_pk_fma_f32 v[4:5], v[4:5], v[20:21], v[22:23] op_sel_hi:[1,0,0]
    v_cvt_pk_bf16_f32 v80, v4, v5
    v_lshlrev_b32 v6, 16, v81
    v_and_b32 v7, s40, v81
    v_pk_add_f32 v[6:7], v[6:7], v[20:21] op_sel:[0,1] op_sel_hi:[1,1]
    v_pk_fma_f32 v[6:7], v[6:7], v[20:21], v[22:23] op_sel_hi:[1,0,0]
    v_cvt_pk_bf16_f32 v81, v6, v7
    v_lshlrev_b32 v4, 16, v82
    v_and_b32 v5, s40, v82
    v_pk_add_f32 v[4:5], v[4:5], v[20:21] op_sel:[0,1] op_sel_hi:[1,1]
    v_pk_fma_f32 v[4:5], v[4:5], v[20:21], v[22:23] op_sel_hi:[1,0,0]
    v_cvt_pk_bf16_f32 v82, v4, v5
    v_lshlrev_b32 v6, 16, v83
    v_and_b32 v7, s40, v83
    v_pk_add_f32 v[6:7], v[6:7], v[20:21] op_sel:[0,1] op_sel_hi:[1,1]
    v_pk_fma_f32 v[6:7], v[6:7], v[20:21], v[22:23] op_sel_hi:[1,0,0]
    v_cvt_pk_bf16_f32 v83, v6, v7
    buffer_store_dwordx4 v[80:83], v1, s[20:23], s35 offen offset:0 sc0 sc1
    v_lshlrev_b32 v4, 16, v84
    v_and_b32 v5, s40, v84
    v_pk_add_f32 v[4:5], v[4:5], v[20:21] op_sel:[0,1] op_sel_hi:[1,1]
    v_pk_fma_f32 v[4:5], v[4:5], v[20:21], v[22:23] op_sel_hi:[1,0,0]
    v_cvt_pk_bf16_f32 v84, v4, v5
    v_lshlrev_b32 v6, 16, v85
    v_and_b32 v7, s40, v85
    v_pk_add_f32 v[6:7], v[6:7], v[20:21] op_sel:[0,1] op_sel_hi:[1,1]
    v_pk_fma_f32 v[6:7], v[6:7], v[20:21], v[22:23] op_sel_hi:[1,0,0]
    v_cvt_pk_bf16_f32 v85, v6, v7
    v_lshlrev_b32 v4, 16, v86
    v_and_b32 v5, s40, v86
    v_pk_add_f32 v[4:5], v[4:5], v[20:21] op_sel:[0,1] op_sel_hi:[1,1]
    v_pk_fma_f32 v[4:5], v[4:5], v[20:21], v[22:23] op_sel_hi:[1,0,0]
    v_cvt_pk_bf16_f32 v86, v4, v5
    v_lshlrev_b32 v6, 16, v87
    v_and_b32 v7, s40, v87
    v_pk_add_f32 v[6:7], v[6:7], v[20:21] op_sel:[0,1] op_sel_hi:[1,1]
    v_pk_fma_f32 v[6:7], v[6:7], v[20:21], v[22:23] op_sel_hi:[1,0,0]
    v_cvt_pk_bf16_f32 v87, v6, v7
    buffer_store_dwordx4 v[84:87], v1, s[20:23], s35 offen offset:1024 sc0 sc1
    buffer_load_dwordx4 v[140:143], v29, s[16:19], s38 offen offset:3072 nt
    v_lshlrev_b32 v4, 16, v88
    v_and_b32 v5, s40, v88
    v_pk_add_f32 v[4:5], v[4:5], v[20:21] op_sel:[0,1] op_sel_hi:[1,1]
    v_pk_fma_f32 v[4:5], v[4:5], v[20:21], v[22:23] op_sel_hi:[1,0,0]
    v_cvt_pk_bf16_f32 v88, v4, v5
    v_lshlrev_b32 v6, 16, v89
    v_and_b32 v7, s40, v89
    v_pk_add_f32 v[6:7], v[6:7], v[20:21] op_sel:[0,1] op_sel_hi:[1,1]
    v_pk_fma_f32 v[6:7], v[6:7], v[20:21], v[22:23] op_sel_hi:[1,0,0]
    v_cvt_pk_bf16_f32 v89, v6, v7
    v_lshlrev_b32 v4, 16, v90
    v_and_b32 v5, s40, v90
    v_pk_add_f32 v[4:5], v[4:5], v[20:21] op_sel:[0,1] op_sel_hi:[1,1]
    v_pk_fma_f32 v[4:5], v[4:5], v[20:21], v[22:23] op_sel_hi:[1,0,0]
    v_cvt_pk_bf16_f32 v90, v4, v5
    v_lshlrev_b32 v6, 16, v91
    v_and_b32 v7, s40, v91
    v_pk_add_f32 v[6:7], v[6:7], v[20:21] op_sel:[0,1] op_sel_hi:[1,1]
    v_pk_fma_f32 v[6:7], v[6:7], v[20:21], v[22:23] op_sel_hi:[1,0,0]
    v_cvt_pk_bf16_f32 v91, v6, v7
    buffer_store_dwordx4 v[88:91], v1, s[20:23], s35 offen offset:2048 sc0 sc1
    buffer_load_dwordx4 v[144:147], v28, s[16:19], s39 offen offset:0 nt
    s_cmp_eq_u32 s24, 0
    s_cbranch_scc0 L_noq1
    s_load_dwordx4 s[52:55], s[14:15], s57 offset:0 glc
L_noq1:
    v_lshlrev_b32 v4, 16, v92
    v_and_b32 v5, s40, v92
    v_pk_add_f32 v[4:5], v[4:5], v[20:21] op_sel:[0,1] op_sel_hi:[1,1]
    v_pk_fma_f32 v[4:5], v[4:5], v[20:21], v[22:23] op_sel_hi:[1,0,0]
    v_cvt_pk_bf16_f32 v92, v4, v5
    v_lshlrev_b32 v6, 16, v93
    v_and_b32 v7, s40, v93
    v_pk_add_f32 v[6:7], v[6:7], v[20:21] op_sel:[0,1] op_sel_hi:[1,1]
    v_pk_fma_f32 v[6:7], v[6:7], v[20:21], v[22:23] op_sel_hi:[1,0,0]
    v_cvt_pk_bf16_f32 v93, v6, v7
    v_lshlrev_b32 v4, 16, v94
    v_and_b32 v5, s40, v94
    v_pk_add_f32 v[4:5], v[4:5], v[20:21] op_sel:[0,1] op_sel_hi:[1,1]
    v_pk_fma_f32 v[4:5], v[4:5], v[20:21], v[22:23] op_sel_hi:[1,0,0]
    v_cvt_pk_bf16_f32 v94, v4, v5
    v_lshlrev_b32 v6, 16, v95
    v_and_b32 v7, s40, v95
    v_pk_add_f32 v[6:7], v[6:7], v[20:21] op_sel:[0,1] op_sel_hi:[1,1]
    v_pk_fma_f32 v[6:7], v[6:7], v[20:21], v[22:23] op_sel_hi:[1,0,0]
    v_cvt_pk_bf16_f32 v95, v6, v7
    buffer_store_dwordx4 v[92:95], v1, s[20:23], s35 offen offset:3072 sc0 sc1
    s_waitcnt vmcnt(12)
    v_mov_b32 v12, 0
    v_mov_b32 v13, 0
    v_dot2c_f32_bf16 v12, s41, v128
    v_dot2c_f32_bf16 v13, v128, v128
    v_dot2c_f32_bf16 v12, s41, v129
    v_dot2c_f32_bf16 v13, v129, v129
    v_dot2c_f32_bf16 v12, s41, v130
    v_dot2c_f32_bf16 v13, v130, v130
    v_dot2c_f32_bf16 v12, s41, v131
    v_dot2c_f32_bf16 v13, v131, v131
    s_cmp_eq_u32 s24, 0
    s_cbranch_scc0 L_get1
    s_mov_b32 s58, 0
    s_branch L_chk1
L_poll1:
    s_load_dwordx4 s[52:55], s[14:15], s57 offset:0 glc
    s_add_u32 s58, s58, 1
    s_cmp_lt_u32 s58, 200000
    s_cbranch_scc0 L_end
L_chk1:
    s_waitcnt lgkmcnt(0)
    s_xor_b32 s60, s53, s49
    s_xor_b32 s61, s55, s49
    s_or_b32 s60, s60, s61
    s_cbranch_scc1 L_poll1
    v_add_f32 v8, s52, v16
    v_subrev_f32 v9, s52, v16
    v_add_f32 v11, s54, v17
    v_mul_f32 v8, 0.5, v8
    v_mul_f32 v10, 0x46800000, v9
    v_fmac_f32 v11, v10, v9
    s_lshl_b32 s61, s45, 16
    s_lshl_b32 s62, s47, 16
    v_cvt_pk_bf16_f32 v9, v8, v8
    v_lshlrev_b32 v9, 16, v9
    v_sub_f32 v8, v8, v9
    v_mul_f32 v8, v8, v8
    v_fmac_f32 v8, 0x37800000, v11
    v_cvt_pk_bf16_f32 v8, v8, v8
    v_lshlrev_b32 v8, 16, v8
    v_add_f32 v8, 0x3727c5ac, v8
    v_cvt_pk_bf16_f32 v8, v8, v8
    v_lshlrev_b32 v8, 16, v8
    v_sqrt_f32 v8, v8
    s_nop 0
    v_cvt_pk_bf16_f32 v8, v8, v8
    v_lshlrev_b32 v8, 16, v8
    v_rcp_f32 v8, v8
    v_mov_b32 v26, s62
    v_mul_f32 v24, s61, v8
    v_xor_b32 v25, 0x80000000, v9
    v_mov_b32 v27, 1
    s_mov_b64 exec, 1
    ds_write_b128 v30, v[24:27] offset:208
    s_mov_b64 exec, -1
    s_branch L_bc1
L_get1:
    s_mov_b32 s58, 0
L_spin1:
    ds_read_b128 v[24:27], v30 offset:208
    s_add_u32 s58, s58, 1
    s_cmp_lt_u32 s58, 1600000
    s_cbranch_scc0 L_end
    s_waitcnt lgkmcnt(0)
    v_cmp_eq_u32 vcc, 0, v27
    s_and_b64 vcc, exec, vcc
    s_cbranch_vccnz L_spin1
L_bc1:
    ds_read_b32 v31, v30 offset:192
    s_waitcnt lgkmcnt(0)
    v_readfirstlane_b32 s60, v31
    s_cmp_lg_u32 s60, 0
    s_cselect_b32 s51, 0, 99
    s_cbranch_scc1 L_gs0
    ds_read_b32 v31, v30 offset:192
    v_lshlrev_b32 v4, 16, v96
    v_and_b32 v5, s40, v96
    v_pk_add_f32 v[4:5], v[4:5], v[24:25] op_sel:[0,1] op_sel_hi:[1,1]
    v_pk_fma_f32 v[4:5], v[4:5], v[24:25], v[26:27] op_sel_hi:[1,0,0]
    v_cvt_pk_bf16_f32 v96, v4, v5
    v_lshlrev_b32 v6, 16, v97
    v_and_b32 v7, s40, v97
    v_pk_add_f32 v[6:7], v[6:7], v[24:25] op_sel:[0,1] op_sel_hi:[1,1]
    v_pk_fma_f32 v[6:7], v[6:7], v[24:25], v[26:27] op_sel_hi:[1,0,0]
    v_cvt_pk_bf16_f32 v97, v6, v7
    v_lshlrev_b32 v4, 16, v98
    v_and_b32 v5, s40, v98
    v_pk_add_f32 v[4:5], v[4:5], v[24:25] op_sel:[0,1] op_sel_hi:[1,1]
    v_pk_fma_f32 v[4:5], v[4:5], v[24:25], v[26:27] op_sel_hi:[1,0,0]
    v_cvt_pk_bf16_f32 v98, v4, v5
    v_lshlrev_b32 v6, 16, v99
    v_and_b32 v7, s40, v99
    v_pk_add_f32 v[6:7], v[6:7], v[24:25] op_sel:[0,1] op_sel_hi:[1,1]
    v_pk_fma_f32 v[6:7], v[6:7], v[24:25], v[26:27] op_sel_hi:[1,0,0]
    v_cvt_pk_bf16_f32 v99, v6, v7
    buffer_store_dwordx4 v[96:99], v1, s[20:23], s36 offen offset:0 sc0 sc1
L_gs0:
    buffer_load_dwordx4 v[148:151], v28, s[16:19], s39 offen offset:1024 nt
    s_cmp_lt_u32 s51, 99
    s_cbranch_scc1 L_gs1
    s_waitcnt lgkmcnt(0)
    v_readfirstlane_b32 s60, v31
    s_cmp_lg_u32 s60, 0
    s_cselect_b32 s51, 1, 99
    s_cbranch_scc1 L_gs1
    ds_read_b32 v31, v30 offset:192
    v_lshlrev_b32 v4, 16, v100
    v_and_b32 v5, s40, v100
    v_pk_add_f32 v[4:5], v[4:5], v[24:25] op_sel:[0,1] op_sel_hi:[1,1]
    v_pk_fma_f32 v[4:5], v[4:5], v[24:25], v[26:27] op_sel_hi:[1,0,0]
    v_cvt_pk_bf16_f32 v100, v4, v5
    v_lshlrev_b32 v6, 16, v101
    v_and_b32 v7, s40, v101
    v_pk_add_f32 v[6:7], v[6:7], v[24:25] op_sel:[0,1] op_sel_hi:[1,1]
    v_pk_fma_f32 v[6:7], v[6:7], v[24:25], v[26:27] op_sel_hi:[1,0,0]
    v_cvt_pk_bf16_f32 v101, v6, v7
    v_lshlrev_b32 v4, 16, v102
    v_and_b32 v5, s40, v102
    v_pk_add_f32 v[4:5], v[4:5], v[24:25] op_sel:[0,1] op_sel_hi:[1,1]
    v_pk_fma_f32 v[4:5], v[4:5], v[24:25], v[26:27] op_sel_hi:[1,0,0]
    v_cvt_pk_bf16_f32 v102, v4, v5
    v_lshlrev_b32 v6, 16, v103
    v_and_b32 v7, s40, v103
    v_pk_add_f32 v[6:7], v[6:7], v[24:25] op_sel:[0,1] op_sel_hi:[1,1]
    v_pk_fma_f32 v[6:7], v[6:7], v[24:25], v[26:27] op_sel_hi:[1,0,0]
    v_cvt_pk_bf16_f32 v103, v6, v7
    buffer_store_dwordx4 v[100:103], v1, s[20:23], s36 offen offset:1024 sc0 sc1
L_gs1:
    v_mov_b32 v3, 1
    s_cmp_lt_u32 s24, 4
    s_cbranch_scc1 L_owatch
    s_mov_b64 exec, 1
    ds_add_u32 v30, v3 offset:196
    s_mov_b64 exec, -1
    s_branch L_odone
L_owatch:
    s_bfe_u32 s64, s56, 0x2000c
    s_bfe_u32 s65, s56, 0x1000a
    s_lshl1_add_u32 s64, s64, s65
    s_lshl1_add_u32 s65, s24, s64
    s_add_u32 s65, s65, 1
    s_and_b32 s66, s65, 1
    s_bfe_u32 s65, s65, 0x20001
    s_lshl2_add_u32 s65, s65, s66
    s_lshl_b32 s65, s65, 10
    s_andn2_b32 s66, s56, 0x3fff
    s_add_u32 s66, s66, s65
    s_mov_b32 s58, 0
L_oloop:
    s_load_dword s60, s[14:15], s66 offset:0x80 glc
    s_add_u32 s58, s58, 1
    s_waitcnt lgkmcnt(0)
    s_cmp_eq_u32 s60, s49
    s_cbranch_scc1 L_ohit
    ds_read_b64 v[4:5], v30 offset:192
    s_waitcnt lgkmcnt(0)
    v_lshl_add_u32 v4, v4, 2, v5
    s_cmp_ge_u32 s58, 16
    v_readfirstlane_b32 s60, v4
    s_cbranch_scc1 L_odone
    s_cmp_lt_u32 s60, 4
    s_cbranch_scc1 L_oloop
    s_branch L_odone
L_ohit:
    ds_write_b32 v30, v3 offset:192
L_odone:
    s_waitcnt lgkmcnt(0)
    s_barrier
    buffer_load_dwordx4 v[152:155], v28, s[16:19], s39 offen offset:2048 nt
    buffer_load_dwordx4 v[156:159], v28, s[16:19], s39 offen offset:3072 nt
    s_barrier
    s_cmp_eq_u32 s24, 7
    s_cbranch_scc0 L_noy
    v_and_b32 v3, 63, v0
    v_lshl_add_u32 v3, v3, 7, s56
    v_mov_b32 v4, s49
    s_mov_b64 exec, 1
    global_store_dword v3, v4, s[14:15] offset:128 sc0 sc1
    s_mov_b64 exec, -1
L_noy:
    v_lshlrev_b32 v4, 16, v104
    v_and_b32 v5, s40, v104
    v_pk_add_f32 v[4:5], v[4:5], v[24:25] op_sel:[0,1] op_sel_hi:[1,1]
    v_pk_fma_f32 v[4:5], v[4:5], v[24:25], v[26:27] op_sel_hi:[1,0,0]
    v_cvt_pk_bf16_f32 v104, v4, v5
    v_lshlrev_b32 v6, 16, v105
    v_and_b32 v7, s40, v105
    v_pk_add_f32 v[6:7], v[6:7], v[24:25] op_sel:[0,1] op_sel_hi:[1,1]
    v_pk_fma_f32 v[6:7], v[6:7], v[24:25], v[26:27] op_sel_hi:[1,0,0]
    v_cvt_pk_bf16_f32 v105, v6, v7
    v_lshlrev_b32 v4, 16, v106
    v_and_b32 v5, s40, v106
    v_pk_add_f32 v[4:5], v[4:5], v[24:25] op_sel:[0,1] op_sel_hi:[1,1]
    v_pk_fma_f32 v[4:5], v[4:5], v[24:25], v[26:27] op_sel_hi:[1,0,0]
    v_cvt_pk_bf16_f32 v106, v4, v5
    v_lshlrev_b32 v6, 16, v107
    v_and_b32 v7, s40, v107
    v_pk_add_f32 v[6:7], v[6:7], v[24:25] op_sel:[0,1] op_sel_hi:[1,1]
    v_pk_fma_f32 v[6:7], v[6:7], v[24:25], v[26:27] op_sel_hi:[1,0,0]
    v_cvt_pk_bf16_f32 v107, v6, v7
    buffer_store_dwordx4 v[104:107], v28, s[20:23], s36 offen offset:2048 sc0 sc1
    v_lshlrev_b32 v4, 16, v108
    v_and_b32 v5, s40, v108
    v_pk_add_f32 v[4:5], v[4:5], v[24:25] op_sel:[0,1] op_sel_hi:[1,1]
    v_pk_fma_f32 v[4:5], v[4:5], v[24:25], v[26:27] op_sel_hi:[1,0,0]
    v_cvt_pk_bf16_f32 v108, v4, v5
    v_lshlrev_b32 v6, 16, v109
    v_and_b32 v7, s40, v109
    v_pk_add_f32 v[6:7], v[6:7], v[24:25] op_sel:[0,1] op_sel_hi:[1,1]
    v_pk_fma_f32 v[6:7], v[6:7], v[24:25], v[26:27] op_sel_hi:[1,0,0]
    v_cvt_pk_bf16_f32 v109, v6, v7
    v_lshlrev_b32 v4, 16, v110
    v_and_b32 v5, s40, v110
    v_pk_add_f32 v[4:5], v[4:5], v[24:25] op_sel:[0,1] op_sel_hi:[1,1]
    v_pk_fma_f32 v[4:5], v[4:5], v[24:25], v[26:27] op_sel_hi:[1,0,0]
    v_cvt_pk_bf16_f32 v110, v4, v5
    v_lshlrev_b32 v6, 16, v111
    v_and_b32 v7, s40, v111
    v_pk_add_f32 v[6:7], v[6:7], v[24:25] op_sel:[0,1] op_sel_hi:[1,1]
    v_pk_fma_f32 v[6:7], v[6:7], v[24:25], v[26:27] op_sel_hi:[1,0,0]
    v_cvt_pk_bf16_f32 v111, v6, v7
    buffer_store_dwordx4 v[108:111], v28, s[20:23], s36 offen offset:3072 sc0 sc1
    v_lshlrev_b32 v4, 16, v112
    v_and_b32 v5, s40, v112
    v_pk_add_f32 v[4:5], v[4:5], v[24:25] op_sel:[0,1] op_sel_hi:[1,1]
    v_pk_fma_f32 v[4:5], v[4:5], v[24:25], v[26:27] op_sel_hi:[1,0,0]
    v_cvt_pk_bf16_f32 v112, v4, v5
    v_lshlrev_b32 v6, 16, v113
    v_and_b32 v7, s40, v113
    v_pk_add_f32 v[6:7], v[6:7], v[24:25] op_sel:[0,1] op_sel_hi:[1,1]
    v_pk_fma_f32 v[6:7], v[6:7], v[24:25], v[26:27] op_sel_hi:[1,0,0]
    v_cvt_pk_bf16_f32 v113, v6, v7
    v_lshlrev_b32 v4, 16, v114
    v_and_b32 v5, s40, v114
    v_pk_add_f32 v[4:5], v[4:5], v[24:25] op_sel:[0,1] op_sel_hi:[1,1]
    v_pk_fma_f32 v[4:5], v[4:5], v[24:25], v[26:27] op_sel_hi:[1,0,0]
    v_cvt_pk_bf16_f32 v114, v4, v5
    v_lshlrev_b32 v6, 16, v115
    v_and_b32 v7, s40, v115
    v_pk_add_f32 v[6:7], v[6:7], v[24:25] op_sel:[0,1] op_sel_hi:[1,1]
    v_pk_fma_f32 v[6:7], v[6:7], v[24:25], v[26:27] op_sel_hi:[1,0,0]
    v_cvt_pk_bf16_f32 v115, v6, v7
    v_lshlrev_b32 v4, 16, v116
    v_and_b32 v5, s40, v116
    v_pk_add_f32 v[4:5], v[4:5], v[24:25] op_sel:[0,1] op_sel_hi:[1,1]
    v_pk_fma_f32 v[4:5], v[4:5], v[24:25], v[26:27] op_sel_hi:[1,0,0]
    v_cvt_pk_bf16_f32 v116, v4, v5
    v_lshlrev_b32 v6, 16, v117
    v_and_b32 v7, s40, v117
    v_pk_add_f32 v[6:7], v[6:7], v[24:25] op_sel:[0,1] op_sel_hi:[1,1]
    v_pk_fma_f32 v[6:7], v[6:7], v[24:25], v[26:27] op_sel_hi:[1,0,0]
    v_cvt_pk_bf16_f32 v117, v6, v7
    v_lshlrev_b32 v4, 16, v118
    v_and_b32 v5, s40, v118
    v_pk_add_f32 v[4:5], v[4:5], v[24:25] op_sel:[0,1] op_sel_hi:[1,1]
    v_pk_fma_f32 v[4:5], v[4:5], v[24:25], v[26:27] op_sel_hi:[1,0,0]
    v_cvt_pk_bf16_f32 v118, v4, v5
    v_lshlrev_b32 v6, 16, v119
    v_and_b32 v7, s40, v119
    v_pk_add_f32 v[6:7], v[6:7], v[24:25] op_sel:[0,1] op_sel_hi:[1,1]
    v_pk_fma_f32 v[6:7], v[6:7], v[24:25], v[26:27] op_sel_hi:[1,0,0]
    v_cvt_pk_bf16_f32 v119, v6, v7
    v_lshlrev_b32 v4, 16, v120
    v_and_b32 v5, s40, v120
    v_pk_add_f32 v[4:5], v[4:5], v[24:25] op_sel:[0,1] op_sel_hi:[1,1]
    v_pk_fma_f32 v[4:5], v[4:5], v[24:25], v[26:27] op_sel_hi:[1,0,0]
    v_cvt_pk_bf16_f32 v120, v4, v5
    v_lshlrev_b32 v6, 16, v121
    v_and_b32 v7, s40, v121
    v_pk_add_f32 v[6:7], v[6:7], v[24:25] op_sel:[0,1] op_sel_hi:[1,1]
    v_pk_fma_f32 v[6:7], v[6:7], v[24:25], v[26:27] op_sel_hi:[1,0,0]
    v_cvt_pk_bf16_f32 v121, v6, v7
    v_lshlrev_b32 v4, 16, v122
    v_and_b32 v5, s40, v122
    v_pk_add_f32 v[4:5], v[4:5], v[24:25] op_sel:[0,1] op_sel_hi:[1,1]
    v_pk_fma_f32 v[4:5], v[4:5], v[24:25], v[26:27] op_sel_hi:[1,0,0]
    v_cvt_pk_bf16_f32 v122, v4, v5
    v_lshlrev_b32 v6, 16, v123
    v_and_b32 v7, s40, v123
    v_pk_add_f32 v[6:7], v[6:7], v[24:25] op_sel:[0,1] op_sel_hi:[1,1]
    v_pk_fma_f32 v[6:7], v[6:7], v[24:25], v[26:27] op_sel_hi:[1,0,0]
    v_cvt_pk_bf16_f32 v123, v6, v7
    s_waitcnt vmcnt(14)
    v_dot2c_f32_bf16 v12, s41, v132
    v_dot2c_f32_bf16 v13, v132, v132
    v_dot2c_f32_bf16 v12, s41, v133
    v_dot2c_f32_bf16 v13, v133, v133
    v_dot2c_f32_bf16 v12, s41, v134
    v_dot2c_f32_bf16 v13, v134, v134
    v_dot2c_f32_bf16 v12, s41, v135
    v_dot2c_f32_bf16 v13, v135, v135
    s_waitcnt vmcnt(11)
    v_dot2c_f32_bf16 v12, s41, v136
    v_dot2c_f32_bf16 v13, v136, v136
    v_dot2c_f32_bf16 v12, s41, v137
    v_dot2c_f32_bf16 v13, v137, v137
    v_dot2c_f32_bf16 v12, s41, v138
    v_dot2c_f32_bf16 v13, v138, v138
    v_dot2c_f32_bf16 v12, s41, v139
    v_dot2c_f32_bf16 v13, v139, v139
    s_waitcnt vmcnt(8)
    v_dot2c_f32_bf16 v12, s41, v140
    v_dot2c_f32_bf16 v13, v140, v140
    v_dot2c_f32_bf16 v12, s41, v141
    v_dot2c_f32_bf16 v13, v141, v141
    v_dot2c_f32_bf16 v12, s41, v142
    v_dot2c_f32_bf16 v13, v142, v142
    v_dot2c_f32_bf16 v12, s41, v143
    v_dot2c_f32_bf16 v13, v143, v143
    s_waitcnt vmcnt(6)
    v_dot2c_f32_bf16 v12, s41, v144
    v_dot2c_f32_bf16 v13, v144, v144
    v_dot2c_f32_bf16 v12, s41, v145
    v_dot2c_f32_bf16 v13, v145, v145
    v_dot2c_f32_bf16 v12, s41, v146
    v_dot2c_f32_bf16 v13, v146, v146
    v_dot2c_f32_bf16 v12, s41, v147
    v_dot2c_f32_bf16 v13, v147, v147
    s_waitcnt vmcnt(4)
    v_dot2c_f32_bf16 v12, s41, v148
    v_dot2c_f32_bf16 v13, v148, v148
    v_dot2c_f32_bf16 v12, s41, v149
    v_dot2c_f32_bf16 v13, v149, v149
    v_dot2c_f32_bf16 v12, s41, v150
    v_dot2c_f32_bf16 v13, v150, v150
    v_dot2c_f32_bf16 v12, s41, v151
    v_dot2c_f32_bf16 v13, v151, v151
    s_waitcnt vmcnt(3)
    v_dot2c_f32_bf16 v12, s41, v152
    v_dot2c_f32_bf16 v13, v152, v152
    v_dot2c_f32_bf16 v12, s41, v153
    v_dot2c_f32_bf16 v13, v153, v153
    v_dot2c_f32_bf16 v12, s41, v154
    v_dot2c_f32_bf16 v13, v154, v154
    v_dot2c_f32_bf16 v12, s41, v155
    v_dot2c_f32_bf16 v13, v155, v155
    s_waitcnt vmcnt(2)
    v_dot2c_f32_bf16 v12, s41, v156
    v_dot2c_f32_bf16 v13, v156, v156
    v_dot2c_f32_bf16 v12, s41, v157
    v_dot2c_f32_bf16 v13, v157, v157
    v_dot2c_f32_bf16 v12, s41, v158
    v_dot2c_f32_bf16 v13, v158, v158
    v_dot2c_f32_bf16 v12, s41, v159
    v_dot2c_f32_bf16 v13, v159, v159
    s_nop 2
    v_mul_f32 v8, 0x3c800000, v12
    v_fma_f32 v10, -v8, v12, v13
    v_readfirstlane_b32 s42, v8
    v_mov_b32 v3, s24
    v_lshlrev_b32 v3, 3, v3
    v_subrev_f32 v8, s42, v8
    v_mul_f32 v9, 0x42800000, v8
    v_fmac_f32 v10, v9, v8
    s_nop 0
    v_add_f32_dpp v8, v8, v8 quad_perm:[1,0,3,2] row_mask:0xf bank_mask:0xf
    v_add_f32_dpp v10, v10, v10 quad_perm:[1,0,3,2] row_mask:0xf bank_mask:0xf
    s_nop 0
    v_add_f32_dpp v8, v8, v8 quad_perm:[2,3,0,1] row_mask:0xf bank_mask:0xf
    v_add_f32_dpp v10, v10, v10 quad_perm:[2,3,0,1] row_mask:0xf bank_mask:0xf
    s_nop 0
    v_add_f32_dpp v8, v8, v8 row_half_mirror row_mask:0xf bank_mask:0xf
    v_add_f32_dpp v10, v10, v10 row_half_mirror row_mask:0xf bank_mask:0xf
    s_nop 0
    v_add_f32_dpp v8, v8, v8 row_mirror row_mask:0xf bank_mask:0xf
    v_add_f32_dpp v10, v10, v10 row_mirror row_mask:0xf bank_mask:0xf
    s_nop 0
    v_add_f32_dpp v8, v8, v8 row_bcast:15 row_mask:0xa bank_mask:0xf
    v_add_f32_dpp v10, v10, v10 row_bcast:15 row_mask:0xa bank_mask:0xf
    s_nop 0
    v_add_f32_dpp v8, v8, v8 row_bcast:31 row_mask:0xc bank_mask:0xf
    v_add_f32_dpp v10, v10, v10 row_bcast:31 row_mask:0xc bank_mask:0xf
    v_mul_f32 v9, 0x3f800000, v8
    v_fma_f32 v11, -v9, v8, v10
    v_mov_b32 v10, s42
    v_fmac_f32 v10, 0x3c800000, v8
    s_mov_b32 exec_lo, 0
    s_brev_b32 exec_hi, 1
    ds_write_b64 v3, v[10:11] offset:128
    s_mov_b64 exec, -1
    buffer_store_dwordx4 v[112:115], v29, s[20:23], s37 offen offset:0 sc0 sc1
    s_waitcnt lgkmcnt(0)
    s_barrier
    s_cmp_eq_u32 s24, 0
    s_cbranch_scc0 L_nopub2
    ds_read_b64 v[10:11], v2 offset:128
    s_waitcnt lgkmcnt(0)
    v_add_f32_dpp v8, v10, v10 quad_perm:[1,0,3,2] row_mask:0xf bank_mask:0xf
    s_nop 1
    v_add_f32_dpp v8, v8, v8 quad_perm:[2,3,0,1] row_mask:0xf bank_mask:0xf
    s_nop 1
    v_add_f32_dpp v8, v8, v8 row_half_mirror row_mask:0xf bank_mask:0xf
    v_mul_f32 v8, 0x3e000000, v8
    v_sub_f32 v9, v10, v8
    v_mul_f32 v10, 0x45800000, v9
    v_fma_f32 v11, v10, v9, v11
    s_nop 1
    v_add_f32_dpp v11, v11, v11 quad_perm:[1,0,3,2] row_mask:0xf bank_mask:0xf
    s_nop 1
    v_add_f32_dpp v11, v11, v11 quad_perm:[2,3,0,1] row_mask:0xf bank_mask:0xf
    s_nop 1
    v_add_f32_dpp v11, v11, v11 row_half_mirror row_mask:0xf bank_mask:0xf
    v_mov_b32 v18, v8
    v_mov_b32 v19, v11
    v_readfirstlane_b32 s64, v8
    v_readfirstlane_b32 s66, v11
    s_mov_b32 s60, s56
    s_not_b32 s61, s49
    s_sub_u32 s64, s64, s61
    s_subb_u32 s65, s49, s61
    s_atomic_add_x2 s[64:65], s[14:15], s60 offset:16
    s_sub_u32 s66, s66, s61
    s_subb_u32 s67, s49, s61
    s_atomic_add_x2 s[66:67], s[14:15], s60 offset:24
L_nopub2:
    s_cmp_eq_u32 s24, 0
    s_cbranch_scc0 L_noq2
    s_load_dwordx4 s[52:55], s[14:15], s57 offset:16 glc
L_noq2:
    buffer_store_dwordx4 v[116:119], v29, s[20:23], s37 offen offset:1024 sc0 sc1
    buffer_store_dwordx4 v[120:123], v29, s[20:23], s37 offen offset:2048 sc0 sc1
    v_lshlrev_b32 v4, 16, v124
    v_and_b32 v5, s40, v124
    v_pk_add_f32 v[4:5], v[4:5], v[24:25] op_sel:[0,1] op_sel_hi:[1,1]
    v_pk_fma_f32 v[4:5], v[4:5], v[24:25], v[26:27] op_sel_hi:[1,0,0]
    v_cvt_pk_bf16_f32 v124, v4, v5
    v_lshlrev_b32 v6, 16, v125
    v_and_b32 v7, s40, v125
    v_pk_add_f32 v[6:7], v[6:7], v[24:25] op_sel:[0,1] op_sel_hi:[1,1]
    v_pk_fma_f32 v[6:7], v[6:7], v[24:25], v[26:27] op_sel_hi:[1,0,0]
    v_cvt_pk_bf16_f32 v125, v6, v7
    v_lshlrev_b32 v4, 16, v126
    v_and_b32 v5, s40, v126
    v_pk_add_f32 v[4:5], v[4:5], v[24:25] op_sel:[0,1] op_sel_hi:[1,1]
    v_pk_fma_f32 v[4:5], v[4:5], v[24:25], v[26:27] op_sel_hi:[1,0,0]
    v_cvt_pk_bf16_f32 v126, v4, v5
    v_lshlrev_b32 v6, 16, v127
    v_and_b32 v7, s40, v127
    v_pk_add_f32 v[6:7], v[6:7], v[24:25] op_sel:[0,1] op_sel_hi:[1,1]
    v_pk_fma_f32 v[6:7], v[6:7], v[24:25], v[26:27] op_sel_hi:[1,0,0]
    v_cvt_pk_bf16_f32 v127, v6, v7
    buffer_store_dwordx4 v[124:127], v29, s[20:23], s37 offen offset:3072 sc0 sc1
    s_cmp_lt_u32 s51, 99
    s_cbranch_scc0 L_edone
    s_cmp_le_u32 s51, 0
    s_cbranch_scc0 L_es0
    v_lshlrev_b32 v4, 16, v96
    v_and_b32 v5, s40, v96
    v_pk_add_f32 v[4:5], v[4:5], v[24:25] op_sel:[0,1] op_sel_hi:[1,1]
    v_pk_fma_f32 v[4:5], v[4:5], v[24:25], v[26:27] op_sel_hi:[1,0,0]
    v_cvt_pk_bf16_f32 v96, v4, v5
    v_lshlrev_b32 v6, 16, v97
    v_and_b32 v7, s40, v97
    v_pk_add_f32 v[6:7], v[6:7], v[24:25] op_sel:[0,1] op_sel_hi:[1,1]
    v_pk_fma_f32 v[6:7], v[6:7], v[24:25], v[26:27] op_sel_hi:[1,0,0]
    v_cvt_pk_bf16_f32 v97, v6, v7
    v_lshlrev_b32 v4, 16, v98
    v_and_b32 v5, s40, v98
    v_pk_add_f32 v[4:5], v[4:5], v[24:25] op_sel:[0,1] op_sel_hi:[1,1]
    v_pk_fma_f32 v[4:5], v[4:5], v[24:25], v[26:27] op_sel_hi:[1,0,0]
    v_cvt_pk_bf16_f32 v98, v4, v5
    v_lshlrev_b32 v6, 16, v99
    v_and_b32 v7, s40, v99
    v_pk_add_f32 v[6:7], v[6:7], v[24:25] op_sel:[0,1] op_sel_hi:[1,1]
    v_pk_fma_f32 v[6:7], v[6:7], v[24:25], v[26:27] op_sel_hi:[1,0,0]
    v_cvt_pk_bf16_f32 v99, v6, v7
    buffer_store_dwordx4 v[96:99], v1, s[20:23], s36 offen offset:0 sc0 sc1
L_es0:
    v_lshlrev_b32 v4, 16, v100
    v_and_b32 v5, s40, v100
    v_pk_add_f32 v[4:5], v[4:5], v[24:25] op_sel:[0,1] op_sel_hi:[1,1]
    v_pk_fma_f32 v[4:5], v[4:5], v[24:25], v[26:27] op_sel_hi:[1,0,0]
    v_cvt_pk_bf16_f32 v100, v4, v5
    v_lshlrev_b32 v6, 16, v101
    v_and_b32 v7, s40, v101
    v_pk_add_f32 v[6:7], v[6:7], v[24:25] op_sel:[0,1] op_sel_hi:[1,1]
    v_pk_fma_f32 v[6:7], v[6:7], v[24:25], v[26:27] op_sel_hi:[1,0,0]
    v_cvt_pk_bf16_f32 v101, v6, v7
    v_lshlrev_b32 v4, 16, v102
    v_and_b32 v5, s40, v102
    v_pk_add_f32 v[4:5], v[4:5], v[24:25] op_sel:[0,1] op_sel_hi:[1,1]
    v_pk_fma_f32 v[4:5], v[4:5], v[24:25], v[26:27] op_sel_hi:[1,0,0]
    v_cvt_pk_bf16_f32 v102, v4, v5
    v_lshlrev_b32 v6, 16, v103
    v_and_b32 v7, s40, v103
    v_pk_add_f32 v[6:7], v[6:7], v[24:25] op_sel:[0,1] op_sel_hi:[1,1]
    v_pk_fma_f32 v[6:7], v[6:7], v[24:25], v[26:27] op_sel_hi:[1,0,0]
    v_cvt_pk_bf16_f32 v103, v6, v7
    buffer_store_dwordx4 v[100:103], v1, s[20:23], s36 offen offset:1024 sc0 sc1
L_es1:
L_edone:
    v_lshlrev_b32 v32, 16, v128
    v_and_b32 v33, s40, v128
    v_lshlrev_b32 v34, 16, v129
    v_and_b32 v35, s40, v129
    v_lshlrev_b32 v36, 16, v130
    v_and_b32 v37, s40, v130
    v_lshlrev_b32 v38, 16, v131
    v_and_b32 v39, s40, v131
    v_lshlrev_b32 v40, 16, v132
    v_and_b32 v41, s40, v132
    v_lshlrev_b32 v42, 16, v133
    v_and_b32 v43, s40, v133
    v_lshlrev_b32 v44, 16, v134
    v_and_b32 v45, s40, v134
    v_lshlrev_b32 v46, 16, v135
    v_and_b32 v47, s40, v135
    v_lshlrev_b32 v48, 16, v136
    v_and_b32 v49, s40, v136
    v_lshlrev_b32 v50, 16, v137
    v_and_b32 v51, s40, v137
    v_lshlrev_b32 v52, 16, v138
    v_and_b32 v53, s40, v138
    v_lshlrev_b32 v54, 16, v139
    v_and_b32 v55, s40, v139
    v_lshlrev_b32 v56, 16, v140
    v_and_b32 v57, s40, v140
    v_lshlrev_b32 v58, 16, v141
    v_and_b32 v59, s40, v141
    v_lshlrev_b32 v60, 16, v142
    v_and_b32 v61, s40, v142
    v_lshlrev_b32 v62, 16, v143
    v_and_b32 v63, s40, v143
    v_lshlrev_b32 v64, 16, v144
    v_and_b32 v65, s40, v144
    v_lshlrev_b32 v66, 16, v145
    v_and_b32 v67, s40, v145
    v_lshlrev_b32 v68, 16, v146
    v_and_b32 v69, s40, v146
    v_lshlrev_b32 v70, 16, v147
    v_and_b32 v71, s40, v147
    v_lshlrev_b32 v72, 16, v148
    v_and_b32 v73, s40, v148
    v_lshlrev_b32 v74, 16, v149
    v_and_b32 v75, s40, v149
    v_lshlrev_b32 v76, 16, v150
    v_and_b32 v77, s40, v150
    v_lshlrev_b32 v78, 16, v151
    v_and_b32 v79, s40, v151
    v_lshlrev_b32 v80, 16, v152
    v_and_b32 v81, s40, v152
    v_lshlrev_b32 v82, 16, v153
    v_and_b32 v83, s40, v153
    v_lshlrev_b32 v84, 16, v154
    v_and_b32 v85, s40, v154
    v_lshlrev_b32 v86, 16, v155
    v_and_b32 v87, s40, v155
    v_lshlrev_b32 v88, 16, v156
    v_and_b32 v89, s40, v156
    v_lshlrev_b32 v90, 16, v157
    v_and_b32 v91, s40, v157
    v_lshlrev_b32 v92, 16, v158
    v_and_b32 v93, s40, v158
    v_lshlrev_b32 v94, 16, v159
    v_and_b32 v95, s40, v159
    s_cmp_eq_u32 s24, 0
    s_cbranch_scc0 L_get2
    s_mov_b32 s58, 0
    s_branch L_chk2
L_poll2:
    s_load_dwordx4 s[52:55], s[14:15], s57 offset:16 glc
    s_add_u32 s58, s58, 1
    s_cmp_lt_u32 s58, 200000
    s_cbranch_scc0 L_end
L_chk2:
    s_waitcnt lgkmcnt(0)
    s_xor_b32 s60, s53, s49
    s_xor_b32 s61, s55, s49
    s_or_b32 s60, s60, s61
    s_cbranch_scc1 L_poll2
    v_add_f32 v8, s52, v18
    v_subrev_f32 v9, s52, v18
    v_add_f32 v11, s54, v19
    v_mul_f32 v8, 0.5, v8
    v_mul_f32 v10, 0x46800000, v9
    v_fmac_f32 v11, v10, v9
    s_and_b32 s61, s45, s40
    s_and_b32 s62, s47, s40
    v_cvt_pk_bf16_f32 v9, v8, v8
    v_lshlrev_b32 v9, 16, v9
    v_sub_f32 v8, v8, v9
    v_mul_f32 v8, v8, v8
    v_fmac_f32 v8, 0x37800000, v11
    v_cvt_pk_bf16_f32 v8, v8, v8
    v_lshlrev_b32 v8, 16, v8
    v_add_f32 v8, 0x3727c5ac, v8
    v_cvt_pk_bf16_f32 v8, v8, v8
    v_lshlrev_b32 v8, 16, v8
    v_sqrt_f32 v8, v8
    s_nop 0
    v_cvt_pk_bf16_f32 v8, v8, v8
    v_lshlrev_b32 v8, 16, v8
    v_rcp_f32 v8, v8
    v_mov_b32 v14, s62
    v_mul_f32 v12, s61, v8
    v_xor_b32 v13, 0x80000000, v9
    v_mov_b32 v15, 1
    s_mov_b64 exec, 1
    ds_write_b128 v30, v[12:15] offset:224
    s_mov_b64 exec, -1
    s_branch L_bc2
L_get2:
    s_mov_b32 s58, 0
L_spin2:
    ds_read_b128 v[12:15], v30 offset:224
    s_add_u32 s58, s58, 1
    s_cmp_lt_u32 s58, 1600000
    s_cbranch_scc0 L_end
    s_waitcnt lgkmcnt(0)
    v_cmp_eq_u32 vcc, 0, v15
    s_and_b64 vcc, exec, vcc
    s_cbranch_vccnz L_spin2
L_bc2:
    v_pk_add_f32 v[32:33], v[32:33], v[12:13] op_sel:[0,1] op_sel_hi:[1,1]
    v_pk_fma_f32 v[32:33], v[32:33], v[12:13], v[14:15] op_sel_hi:[1,0,0]
    v_cvt_pk_bf16_f32 v128, v32, v33
    v_pk_add_f32 v[34:35], v[34:35], v[12:13] op_sel:[0,1] op_sel_hi:[1,1]
    v_pk_fma_f32 v[34:35], v[34:35], v[12:13], v[14:15] op_sel_hi:[1,0,0]
    v_cvt_pk_bf16_f32 v129, v34, v35
    v_pk_add_f32 v[36:37], v[36:37], v[12:13] op_sel:[0,1] op_sel_hi:[1,1]
    v_pk_fma_f32 v[36:37], v[36:37], v[12:13], v[14:15] op_sel_hi:[1,0,0]
    v_cvt_pk_bf16_f32 v130, v36, v37
    v_pk_add_f32 v[38:39], v[38:39], v[12:13] op_sel:[0,1] op_sel_hi:[1,1]
    v_pk_fma_f32 v[38:39], v[38:39], v[12:13], v[14:15] op_sel_hi:[1,0,0]
    v_cvt_pk_bf16_f32 v131, v38, v39
    buffer_store_dwordx4 v[128:131], v29, s[20:23], s38 offen offset:0 sc0 sc1
    v_pk_add_f32 v[40:41], v[40:41], v[12:13] op_sel:[0,1] op_sel_hi:[1,1]
    v_pk_fma_f32 v[40:41], v[40:41], v[12:13], v[14:15] op_sel_hi:[1,0,0]
    v_cvt_pk_bf16_f32 v132, v40, v41
    v_pk_add_f32 v[42:43], v[42:43], v[12:13] op_sel:[0,1] op_sel_hi:[1,1]
    v_pk_fma_f32 v[42:43], v[42:43], v[12:13], v[14:15] op_sel_hi:[1,0,0]
    v_cvt_pk_bf16_f32 v133, v42, v43
    v_pk_add_f32 v[44:45], v[44:45], v[12:13] op_sel:[0,1] op_sel_hi:[1,1]
    v_pk_fma_f32 v[44:45], v[44:45], v[12:13], v[14:15] op_sel_hi:[1,0,0]
    v_cvt_pk_bf16_f32 v134, v44, v45
    v_pk_add_f32 v[46:47], v[46:47], v[12:13] op_sel:[0,1] op_sel_hi:[1,1]
    v_pk_fma_f32 v[46:47], v[46:47], v[12:13], v[14:15] op_sel_hi:[1,0,0]
    v_cvt_pk_bf16_f32 v135, v46, v47
    buffer_store_dwordx4 v[132:135], v29, s[20:23], s38 offen offset:1024 sc0 sc1
    v_pk_add_f32 v[48:49], v[48:49], v[12:13] op_sel:[0,1] op_sel_hi:[1,1]
    v_pk_fma_f32 v[48:49], v[48:49], v[12:13], v[14:15] op_sel_hi:[1,0,0]
    v_cvt_pk_bf16_f32 v136, v48, v49
    v_pk_add_f32 v[50:51], v[50:51], v[12:13] op_sel:[0,1] op_sel_hi:[1,1]
    v_pk_fma_f32 v[50:51], v[50:51], v[12:13], v[14:15] op_sel_hi:[1,0,0]
    v_cvt_pk_bf16_f32 v137, v50, v51
    v_pk_add_f32 v[52:53], v[52:53], v[12:13] op_sel:[0,1] op_sel_hi:[1,1]
    v_pk_fma_f32 v[52:53], v[52:53], v[12:13], v[14:15] op_sel_hi:[1,0,0]
    v_cvt_pk_bf16_f32 v138, v52, v53
    v_pk_add_f32 v[54:55], v[54:55], v[12:13] op_sel:[0,1] op_sel_hi:[1,1]
    v_pk_fma_f32 v[54:55], v[54:55], v[12:13], v[14:15] op_sel_hi:[1,0,0]
    v_cvt_pk_bf16_f32 v139, v54, v55
    buffer_store_dwordx4 v[136:139], v29, s[20:23], s38 offen offset:2048 sc0 sc1
    v_pk_add_f32 v[56:57], v[56:57], v[12:13] op_sel:[0,1] op_sel_hi:[1,1]
    v_pk_fma_f32 v[56:57], v[56:57], v[12:13], v[14:15] op_sel_hi:[1,0,0]
    v_cvt_pk_bf16_f32 v140, v56, v57
    v_pk_add_f32 v[58:59], v[58:59], v[12:13] op_sel:[0,1] op_sel_hi:[1,1]
    v_pk_fma_f32 v[58:59], v[58:59], v[12:13], v[14:15] op_sel_hi:[1,0,0]
    v_cvt_pk_bf16_f32 v141, v58, v59
    v_pk_add_f32 v[60:61], v[60:61], v[12:13] op_sel:[0,1] op_sel_hi:[1,1]
    v_pk_fma_f32 v[60:61], v[60:61], v[12:13], v[14:15] op_sel_hi:[1,0,0]
    v_cvt_pk_bf16_f32 v142, v60, v61
    v_pk_add_f32 v[62:63], v[62:63], v[12:13] op_sel:[0,1] op_sel_hi:[1,1]
    v_pk_fma_f32 v[62:63], v[62:63], v[12:13], v[14:15] op_sel_hi:[1,0,0]
    v_cvt_pk_bf16_f32 v143, v62, v63
    buffer_store_dwordx4 v[140:143], v29, s[20:23], s38 offen offset:3072 sc0 sc1
    v_pk_add_f32 v[64:65], v[64:65], v[12:13] op_sel:[0,1] op_sel_hi:[1,1]
    v_pk_fma_f32 v[64:65], v[64:65], v[12:13], v[14:15] op_sel_hi:[1,0,0]
    v_cvt_pk_bf16_f32 v144, v64, v65
    v_pk_add_f32 v[66:67], v[66:67], v[12:13] op_sel:[0,1] op_sel_hi:[1,1]
    v_pk_fma_f32 v[66:67], v[66:67], v[12:13], v[14:15] op_sel_hi:[1,0,0]
    v_cvt_pk_bf16_f32 v145, v66, v67
    v_pk_add_f32 v[68:69], v[68:69], v[12:13] op_sel:[0,1] op_sel_hi:[1,1]
    v_pk_fma_f32 v[68:69], v[68:69], v[12:13], v[14:15] op_sel_hi:[1,0,0]
    v_cvt_pk_bf16_f32 v146, v68, v69
    v_pk_add_f32 v[70:71], v[70:71], v[12:13] op_sel:[0,1] op_sel_hi:[1,1]
    v_pk_fma_f32 v[70:71], v[70:71], v[12:13], v[14:15] op_sel_hi:[1,0,0]
    v_cvt_pk_bf16_f32 v147, v70, v71
    buffer_store_dwordx4 v[144:147], v28, s[20:23], s39 offen offset:0 sc0 sc1
    v_pk_add_f32 v[72:73], v[72:73], v[12:13] op_sel:[0,1] op_sel_hi:[1,1]
    v_pk_fma_f32 v[72:73], v[72:73], v[12:13], v[14:15] op_sel_hi:[1,0,0]
    v_cvt_pk_bf16_f32 v148, v72, v73
    v_pk_add_f32 v[74:75], v[74:75], v[12:13] op_sel:[0,1] op_sel_hi:[1,1]
    v_pk_fma_f32 v[74:75], v[74:75], v[12:13], v[14:15] op_sel_hi:[1,0,0]
    v_cvt_pk_bf16_f32 v149, v74, v75
    v_pk_add_f32 v[76:77], v[76:77], v[12:13] op_sel:[0,1] op_sel_hi:[1,1]
    v_pk_fma_f32 v[76:77], v[76:77], v[12:13], v[14:15] op_sel_hi:[1,0,0]
    v_cvt_pk_bf16_f32 v150, v76, v77
    v_pk_add_f32 v[78:79], v[78:79], v[12:13] op_sel:[0,1] op_sel_hi:[1,1]
    v_pk_fma_f32 v[78:79], v[78:79], v[12:13], v[14:15] op_sel_hi:[1,0,0]
    v_cvt_pk_bf16_f32 v151, v78, v79
    buffer_store_dwordx4 v[148:151], v28, s[20:23], s39 offen offset:1024 sc0 sc1
    v_pk_add_f32 v[80:81], v[80:81], v[12:13] op_sel:[0,1] op_sel_hi:[1,1]
    v_pk_fma_f32 v[80:81], v[80:81], v[12:13], v[14:15] op_sel_hi:[1,0,0]
    v_cvt_pk_bf16_f32 v152, v80, v81
    v_pk_add_f32 v[82:83], v[82:83], v[12:13] op_sel:[0,1] op_sel_hi:[1,1]
    v_pk_fma_f32 v[82:83], v[82:83], v[12:13], v[14:15] op_sel_hi:[1,0,0]
    v_cvt_pk_bf16_f32 v153, v82, v83
    v_pk_add_f32 v[84:85], v[84:85], v[12:13] op_sel:[0,1] op_sel_hi:[1,1]
    v_pk_fma_f32 v[84:85], v[84:85], v[12:13], v[14:15] op_sel_hi:[1,0,0]
    v_cvt_pk_bf16_f32 v154, v84, v85
    v_pk_add_f32 v[86:87], v[86:87], v[12:13] op_sel:[0,1] op_sel_hi:[1,1]
    v_pk_fma_f32 v[86:87], v[86:87], v[12:13], v[14:15] op_sel_hi:[1,0,0]
    v_cvt_pk_bf16_f32 v155, v86, v87
    buffer_store_dwordx4 v[152:155], v28, s[20:23], s39 offen offset:2048 sc0 sc1
    v_pk_add_f32 v[88:89], v[88:89], v[12:13] op_sel:[0,1] op_sel_hi:[1,1]
    v_pk_fma_f32 v[88:89], v[88:89], v[12:13], v[14:15] op_sel_hi:[1,0,0]
    v_cvt_pk_bf16_f32 v156, v88, v89
    v_pk_add_f32 v[90:91], v[90:91], v[12:13] op_sel:[0,1] op_sel_hi:[1,1]
    v_pk_fma_f32 v[90:91], v[90:91], v[12:13], v[14:15] op_sel_hi:[1,0,0]
    v_cvt_pk_bf16_f32 v157, v90, v91
    v_pk_add_f32 v[92:93], v[92:93], v[12:13] op_sel:[0,1] op_sel_hi:[1,1]
    v_pk_fma_f32 v[92:93], v[92:93], v[12:13], v[14:15] op_sel_hi:[1,0,0]
    v_cvt_pk_bf16_f32 v158, v92, v93
    v_pk_add_f32 v[94:95], v[94:95], v[12:13] op_sel:[0,1] op_sel_hi:[1,1]
    v_pk_fma_f32 v[94:95], v[94:95], v[12:13], v[14:15] op_sel_hi:[1,0,0]
    v_cvt_pk_bf16_f32 v159, v94, v95
    buffer_store_dwordx4 v[156:159], v28, s[20:23], s39 offen offset:3072 sc0 sc1
L_last:
L_end:
    s_endpgm
.section .rodata,"a"
.p2align 6
.amdhsa_kernel standalone__instancenorm__prompt_kernel
  .amdhsa_next_free_vgpr 160
  .amdhsa_next_free_sgpr 72
  .amdhsa_accum_offset 160
  .amdhsa_group_segment_fixed_size 0
  .amdhsa_kernarg_size 48
  .amdhsa_user_sgpr_count 2
  .amdhsa_user_sgpr_kernarg_segment_ptr 1
  .amdhsa_system_sgpr_workgroup_id_x 1
  .amdhsa_float_denorm_mode_32 3
.end_amdhsa_kernel
```
